```python
import torch

def _softmax(x, axis=-1):
    return torch.softmax(x, dim=axis)
def _gelu(x):
    return torch.nn.functional.gelu(x, approximate="tanh")
def _silu(x):
    return torch.nn.functional.silu(x)
def _sigmoid(x):
    return torch.sigmoid(x)
def _layernorm(x, axis=-1, eps=1e-5):
    m = x.mean(dim=axis, keepdim=True)
    v = x.var(dim=axis, keepdim=True, unbiased=False)
    return (x - m) / torch.sqrt(v + eps)
def _scatter_add(tgt, idx, src, axis=0):
    return tgt.clone().index_add_(axis, idx, src)
def _segment_sum(src, seg, n):
    out = torch.zeros((n,) + src.shape[1:], dtype=src.dtype)
    return out.index_add_(0, seg, src)
def _pad(x, pw):
    flat = tuple(v for pair in reversed(pw) for v in pair)
    return torch.nn.functional.pad(x, flat)

kernel_name = 'parallel_sum__gqa_block_cached__glu_gated_glu__decode'

def setup_inputs():

    _w = (lambda a: (lambda t: t.to(torch.bfloat16) if t.is_floating_point() else t)(torch.as_tensor(a)))
    def _A_setup():
        B, Sq, D = 2, 1, 640
        Hq, Hkv, Sk, Dh = 32, 32, 8192, 192
        assert Hq % Hkv == 0, (Hq, Hkv)
        return {
            "x": _w((lambda *s: torch.randn(*s, dtype=torch.bfloat16) * 0.05)(B, Sq, D)),
            "k_cache": _w((lambda *s: torch.randn(*s, dtype=torch.bfloat16) * 3.2)(B, Hkv, Sk, Dh)),
            "v_cache": _w((lambda *s: torch.randn(*s, dtype=torch.bfloat16) * 1.6)(B, Hkv, Sk, Dh)),
            "wq": _w((lambda *s: torch.randn(*s, dtype=torch.bfloat16) * 3.2)(D, Hq * Dh) * (D ** -0.5)),
            "wo": _w((lambda *s: torch.randn(*s, dtype=torch.bfloat16) * 1.6)(Hq * Dh, D) * ((Hq * Dh) ** -0.5)),
        }
    _A_in = _A_setup()

    def _B_setup():
        B, S, D, F = 2, 1, 640, 1536
        return {
            "x": _w((lambda *s: torch.randn(*s, dtype=torch.bfloat16) * 0.05)(B, S, D)),
            "w_gate": _w((lambda *s: torch.randn(*s, dtype=torch.bfloat16) * 0.2)(D, F)),
            "w_up": _w((lambda *s: torch.randn(*s, dtype=torch.bfloat16) * 0.05)(D, F)),
            "w_down": _w((lambda *s: torch.randn(*s, dtype=torch.bfloat16) * 0.05)(F, D)),
        }
    _B_in = _B_setup()

    return {
        "A_x": _A_in["x"],
        "A_k_cache": _A_in["k_cache"],
        "A_v_cache": _A_in["v_cache"],
        "A_wq": _A_in["wq"],
        "A_wo": _A_in["wo"],
        "B_x": _B_in["x"],
        "B_w_gate": _B_in["w_gate"],
        "B_w_up": _B_in["w_up"],
        "B_w_down": _B_in["w_down"],
    }

def reference(A_x, A_k_cache, A_v_cache, A_wq, A_wo, B_x, B_w_gate, B_w_up, B_w_down):
    def _A_ref(x, k_cache, v_cache, wq, wo):
        B, Sq, D = x.shape
        Hq, Dh = 32, 192
        Hkv = k_cache.shape[1]
        rep = Hq // Hkv
        q = (lambda x, *d: x.permute(*d))((x @ wq).reshape(B, Sq, Hq, Dh), 0, 2, 1, 3)
        k = (lambda x, n, axis: torch.repeat_interleave(x, n, dim=axis))(k_cache, rep, axis=1)
        v = (lambda x, n, axis: torch.repeat_interleave(x, n, dim=axis))(v_cache, rep, axis=1)
        scores = torch.einsum("bhqd,bhkd->bhqk", q, k) * (Dh ** -0.5)
        p = _softmax(scores, axis=-1)
        o = torch.einsum("bhqk,bhkd->bhqd", p, v)
        return (lambda x, *d: x.permute(*d))(o, 0, 2, 1, 3).reshape(B, Sq, Hq * Dh) @ wo

    def _B_ref(x, w_gate, w_up, w_down):
        g = torch.einsum("bsd,df->bsf", x, w_gate)
        u = torch.einsum("bsd,df->bsf", x, w_up)
        h = _sigmoid(g) * u
        return torch.einsum("bsf,fd->bsd", h, w_down)

    x = A_x
    xn = _layernorm(x, axis=-1)
    return x + _A_ref(xn, A_k_cache, A_v_cache, A_wq, A_wo) + _B_ref(xn, B_w_gate, B_w_up, B_w_down)
```

```asm
; @launch grid=(256,1,1) block=(512,1,1) lds=63488
.amdgcn_target "amdgcn-amd-amdhsa--gfx950"
.text
.globl parallel_sum__gqa_block_cached__glu_gated_glu__decode_kernel
.p2align 8
.type parallel_sum__gqa_block_cached__glu_gated_glu__decode_kernel,@function
parallel_sum__gqa_block_cached__glu_gated_glu__decode_kernel:
  s_cmp_ge_u32 s2, 256
  s_cbranch_scc1 L_end
  s_load_dwordx16 s[16:31], s[0:1], 0
  s_load_dwordx8 s[32:39], s[0:1], 64
  v_lshrrev_b32 v6, 6, v0
  v_and_b32 v0, 63, v0
  v_readfirstlane_b32 s4, v6
  s_and_b32 s3, s2, 7
  s_lshr_b32 s8, s2, 3
  s_and_b32 s5, s8, 0x18
  s_add_u32 s5, s5, s3
  s_and_b32 s6, s8, 7
  s_lshl_b32 s7, s5, 3
  s_add_u32 s7, s7, s6
  s_cmp_ge_u32 s4, 4
  s_cbranch_scc1 L_service
L_stream:
  v_lshrrev_b32 v6, 3, v0
  v_and_b32 v7, 7, v0
  v_mul_u32_u24 v1, 0x180, v6
  v_lshl_add_u32 v1, v7, 4, v1
  s_lshl_b32 s10, s8, 2
  s_add_u32 s10, s10, s4
  s_mul_i32 s10, s10, 3072
  v_add_u32 v1, s10, v1
  s_mov_b32 s74, 0
  s_mov_b32 s75, 1966080
  s_mov_b32 s76, 786432
  s_mov_b32 s77, 2752512
  s_mov_b32 s78, 1572864
  s_mov_b32 s79, 393216
  s_mov_b32 s80, 2359296
  s_mov_b32 s81, 1179648
  s_mul_i32 s10, s3, 3145728
  s_memrealtime s[88:89]
  s_waitcnt lgkmcnt(0)
  s_add_u32 s40, s18, s10
  s_addc_u32 s41, s19, 0
  s_mov_b32 s42, 3145728
  s_mov_b32 s43, 0x20000
  buffer_load_dwordx4 v[64:67], v1, s[40:43], s74 offen offset:0 nt
  buffer_load_dwordx4 v[68:71], v1, s[40:43], s74 offen offset:128 nt
  s_barrier
  s_sub_u32 s10, s10, 25165824
  s_ashr_i32 s11, s10, 31
  s_add_u32 s20, s20, s10
  s_addc_u32 s21, s21, s11
  s_mov_b32 s91, s88
  s_movk_i32 s90, 935
  s_mov_b32 s92, 0
  v_and_b32 v8, 1, v0
  v_lshlrev_b32 v8, 4, v8
  v_mov_b32 v9, 0xffff
  v_lshlrev_b32 v8, v8, v9
  v_bfe_u32 v9, v0, 1, 2
  v_cmp_eq_u32 vcc, 0, v9
  s_nop 1
  v_cndmask_b32 v2, 0, v8, vcc
  v_cmp_eq_u32 vcc, 1, v9
  s_nop 1
  v_cndmask_b32 v3, 0, v8, vcc
  v_cmp_eq_u32 vcc, 2, v9
  s_nop 1
  v_cndmask_b32 v4, 0, v8, vcc
  v_cmp_eq_u32 vcc, 3, v9
  s_nop 1
  v_cndmask_b32 v5, 0, v8, vcc
  s_mov_b32 s68, 0x3fb8aa3b
  v_lshlrev_b32 v49, 4, v7
  v_lshrrev_b32 v40, 5, v0
  s_lshl_b32 s10, s4, 1
  v_add_u32 v40, s10, v40
  v_mul_u32_u24 v40, 768, v40
  v_lshl_add_u32 v40, v7, 5, v40
  v_and_b32 v9, 16, v0
  v_add_u32 v40, v40, v9
  v_lshrrev_b32 v41, 4, v0
  v_lshlrev_b32 v41, 5, v41
  s_lshl_b32 s10, s4, 3
  v_add_u32 v41, s10, v41
  s_lshl_b32 s10, s4, 4
  v_mov_b32 v48, s10
  v_mov_b32 v43, 0
  s_waitcnt vmcnt(1)
  buffer_load_dwordx4 v[72:75], v1, s[40:43], s74 offen offset:256 nt
  s_waitcnt vmcnt(1)
  buffer_load_dwordx4 v[76:79], v1, s[40:43], s75 offen offset:0 nt
  s_waitcnt vmcnt(1)
  buffer_load_dwordx4 v[80:83], v1, s[40:43], s75 offen offset:128 nt
  s_waitcnt vmcnt(1)
  buffer_load_dwordx4 v[84:87], v1, s[40:43], s75 offen offset:256 nt
  s_waitcnt vmcnt(1)
  buffer_load_dwordx4 v[88:91], v1, s[40:43], s76 offen offset:0 nt
  s_waitcnt vmcnt(1)
  buffer_load_dwordx4 v[92:95], v1, s[40:43], s76 offen offset:128 nt
  s_waitcnt vmcnt(5)
  buffer_load_dwordx4 v[96:99], v1, s[40:43], s76 offen offset:256 nt
  s_waitcnt vmcnt(5)
  buffer_load_dwordx4 v[100:103], v1, s[40:43], s77 offen offset:0 nt
  s_waitcnt vmcnt(5)
  buffer_load_dwordx4 v[104:107], v1, s[40:43], s77 offen offset:128 nt
  s_waitcnt vmcnt(5)
  buffer_load_dwordx4 v[108:111], v1, s[40:43], s77 offen offset:256 nt
  s_waitcnt vmcnt(5)
  buffer_load_dwordx4 v[112:115], v1, s[40:43], s78 offen offset:0 nt
  s_waitcnt vmcnt(5)
  buffer_load_dwordx4 v[116:119], v1, s[40:43], s78 offen offset:128 nt
  s_waitcnt vmcnt(5)
  buffer_load_dwordx4 v[120:123], v1, s[40:43], s78 offen offset:256 nt
  s_waitcnt vmcnt(5)
  buffer_load_dwordx4 v[124:127], v1, s[40:43], s79 offen offset:0 nt
  s_waitcnt vmcnt(5)
  buffer_load_dwordx4 v[128:131], v1, s[40:43], s79 offen offset:128 nt
  s_waitcnt vmcnt(5)
  buffer_load_dwordx4 v[132:135], v1, s[40:43], s79 offen offset:256 nt
  s_waitcnt vmcnt(5)
  buffer_load_dwordx4 v[136:139], v1, s[40:43], s80 offen offset:0 nt
  s_waitcnt vmcnt(5)
  buffer_load_dwordx4 v[140:143], v1, s[40:43], s80 offen offset:128 nt
  s_waitcnt vmcnt(5)
  buffer_load_dwordx4 v[144:147], v1, s[40:43], s80 offen offset:256 nt
  s_waitcnt vmcnt(5)
  buffer_load_dwordx4 v[148:151], v1, s[40:43], s81 offen offset:0 nt
  s_waitcnt vmcnt(5)
  buffer_load_dwordx4 v[152:155], v1, s[40:43], s81 offen offset:128 nt
  s_waitcnt vmcnt(5)
  buffer_load_dwordx4 v[156:159], v1, s[40:43], s81 offen offset:256 nt
  s_add_u32 s40, s40, 25165824
  s_addc_u32 s41, s41, 0
  s_waitcnt vmcnt(5)
  buffer_load_dwordx4 v[160:163], v1, s[40:43], s74 offen offset:0 nt
  s_waitcnt vmcnt(5)
  buffer_load_dwordx4 v[164:167], v1, s[40:43], s74 offen offset:128 nt
  s_waitcnt vmcnt(5)
  buffer_load_dwordx4 v[168:171], v1, s[40:43], s74 offen offset:256 nt
  s_waitcnt vmcnt(5)
  buffer_load_dwordx4 v[172:175], v1, s[40:43], s75 offen offset:0 nt
  s_waitcnt vmcnt(5)
  buffer_load_dwordx4 v[176:179], v1, s[40:43], s75 offen offset:128 nt
  s_waitcnt vmcnt(5)
  buffer_load_dwordx4 v[180:183], v1, s[40:43], s75 offen offset:256 nt
  s_waitcnt vmcnt(5)
  buffer_load_dwordx4 v[184:187], v1, s[40:43], s76 offen offset:0 nt
  s_waitcnt vmcnt(5)
  buffer_load_dwordx4 v[188:191], v1, s[40:43], s76 offen offset:128 nt
  s_waitcnt vmcnt(5)
  buffer_load_dwordx4 v[192:195], v1, s[40:43], s76 offen offset:256 nt
  s_waitcnt vmcnt(5)
  buffer_load_dwordx4 v[196:199], v1, s[40:43], s77 offen offset:0 nt
  s_waitcnt vmcnt(5)
  buffer_load_dwordx4 v[200:203], v1, s[40:43], s77 offen offset:128 nt
  s_waitcnt vmcnt(5)
  buffer_load_dwordx4 v[204:207], v1, s[40:43], s77 offen offset:256 nt
  s_waitcnt vmcnt(5)
  buffer_load_dwordx4 v[208:211], v1, s[40:43], s78 offen offset:0 nt
  s_waitcnt vmcnt(5)
  buffer_load_dwordx4 v[212:215], v1, s[40:43], s78 offen offset:128 nt
  s_waitcnt vmcnt(5)
  buffer_load_dwordx4 v[216:219], v1, s[40:43], s78 offen offset:256 nt
  s_waitcnt vmcnt(5)
  buffer_load_dwordx4 v[220:223], v1, s[40:43], s79 offen offset:0 nt
  s_waitcnt vmcnt(5)
  buffer_load_dwordx4 v[224:227], v1, s[40:43], s79 offen offset:128 nt
  s_waitcnt vmcnt(5)
  buffer_load_dwordx4 v[228:231], v1, s[40:43], s79 offen offset:256 nt
  s_waitcnt vmcnt(5)
  buffer_load_dwordx4 v[232:235], v1, s[40:43], s80 offen offset:0 nt
  s_waitcnt vmcnt(5)
  buffer_load_dwordx4 v[236:239], v1, s[40:43], s80 offen offset:128 nt
  s_waitcnt vmcnt(5)
  buffer_load_dwordx4 v[240:243], v1, s[40:43], s80 offen offset:256 nt
  s_waitcnt vmcnt(5)
  buffer_load_dwordx4 v[244:247], v1, s[40:43], s81 offen offset:0 nt
  s_waitcnt vmcnt(5)
  buffer_load_dwordx4 v[248:251], v1, s[40:43], s81 offen offset:128 nt
  s_waitcnt vmcnt(5)
  buffer_load_dwordx4 v[252:255], v1, s[40:43], s81 offen offset:256 nt
  s_mov_b32 s15, 0
L_qw:
  ds_read_b32 v42, v43 offset:3844
  ds_read_b128 v[16:19], v49 offset:0
  ds_read_b128 v[20:23], v49 offset:128
  ds_read_b128 v[24:27], v49 offset:256
  s_waitcnt lgkmcnt(0)
  v_cmp_eq_u32 vcc, 0, v42
  s_cbranch_vccz L_qw_ok
  s_sleep 2
  s_add_u32 s15, s15, 1
  s_cmp_lt_u32 s15, 692307
  s_cbranch_scc1 L_qw
L_qw_ok:
  v_mov_b32 v35, v34
  v_mov_b32 v34, v33
  v_mov_b32 v33, v32
  v_mov_b32 v32, v31
  v_mov_b32 v31, v30
  v_mov_b32 v30, v29
  v_mov_b32 v29, v28
  v_add_u32 v49, 384, v49
  s_mov_b32 vcc_lo, 0x01010101
  s_mov_b32 vcc_hi, 0x01010101
  v_mov_b32 v6, 0
  v_dot2c_f32_bf16 v6, v64, v16
  v_dot2c_f32_bf16 v6, v65, v17
  v_dot2c_f32_bf16 v6, v66, v18
  v_dot2c_f32_bf16 v6, v67, v19
  v_dot2c_f32_bf16 v6, v68, v20
  v_dot2c_f32_bf16 v6, v69, v21
  v_dot2c_f32_bf16 v6, v70, v22
  v_dot2c_f32_bf16 v6, v71, v23
  s_add_u32 s40, s40, 25165824
  s_addc_u32 s41, s41, 0
  s_waitcnt vmcnt(4)
  buffer_load_dwordx4 v[64:67], v1, s[40:43], s74 offen offset:0 nt
  v_dot2c_f32_bf16 v6, v72, v24
  v_dot2c_f32_bf16 v6, v73, v25
  v_dot2c_f32_bf16 v6, v74, v26
  v_dot2c_f32_bf16 v6, v75, v27
  s_nop 2
  v_add_f32_dpp v6, v6, v6 quad_perm:[1,0,3,2] row_mask:0xf bank_mask:0xf
  s_nop 1
  v_add_f32_dpp v6, v6, v6 quad_perm:[2,3,0,1] row_mask:0xf bank_mask:0xf
  s_nop 1
  v_add_f32_dpp v6, v6, v6 row_half_mirror row_mask:0xf bank_mask:0xf
  v_cndmask_b32 v28, v28, v6, vcc
  s_lshl_b64 vcc, vcc, 1
  v_mov_b32 v7, 0
  v_dot2c_f32_bf16 v7, v76, v16
  v_dot2c_f32_bf16 v7, v77, v17
  v_dot2c_f32_bf16 v7, v78, v18
  v_dot2c_f32_bf16 v7, v79, v19
  v_dot2c_f32_bf16 v7, v80, v20
  v_dot2c_f32_bf16 v7, v81, v21
  v_dot2c_f32_bf16 v7, v82, v22
  v_dot2c_f32_bf16 v7, v83, v23
  v_dot2c_f32_bf16 v7, v84, v24
  v_dot2c_f32_bf16 v7, v85, v25
  v_dot2c_f32_bf16 v7, v86, v26
  v_dot2c_f32_bf16 v7, v87, v27
  s_nop 2
  v_add_f32_dpp v7, v7, v7 quad_perm:[1,0,3,2] row_mask:0xf bank_mask:0xf
  s_nop 1
  v_add_f32_dpp v7, v7, v7 quad_perm:[2,3,0,1] row_mask:0xf bank_mask:0xf
  s_nop 1
  v_add_f32_dpp v7, v7, v7 row_half_mirror row_mask:0xf bank_mask:0xf
  v_cndmask_b32 v28, v28, v7, vcc
  s_lshl_b64 vcc, vcc, 1
  v_mov_b32 v6, 0
  v_dot2c_f32_bf16 v6, v88, v16
  v_dot2c_f32_bf16 v6, v89, v17
  v_dot2c_f32_bf16 v6, v90, v18
  v_dot2c_f32_bf16 v6, v91, v19
  v_dot2c_f32_bf16 v6, v92, v20
  v_dot2c_f32_bf16 v6, v93, v21
  v_dot2c_f32_bf16 v6, v94, v22
  v_dot2c_f32_bf16 v6, v95, v23
  s_waitcnt vmcnt(4)
  buffer_load_dwordx4 v[68:71], v1, s[40:43], s74 offen offset:128 nt
  v_dot2c_f32_bf16 v6, v96, v24
  v_dot2c_f32_bf16 v6, v97, v25
  v_dot2c_f32_bf16 v6, v98, v26
  v_dot2c_f32_bf16 v6, v99, v27
  s_nop 2
  v_add_f32_dpp v6, v6, v6 quad_perm:[1,0,3,2] row_mask:0xf bank_mask:0xf
  s_nop 1
  v_add_f32_dpp v6, v6, v6 quad_perm:[2,3,0,1] row_mask:0xf bank_mask:0xf
  s_nop 1
  v_add_f32_dpp v6, v6, v6 row_half_mirror row_mask:0xf bank_mask:0xf
  v_cndmask_b32 v28, v28, v6, vcc
  s_lshl_b64 vcc, vcc, 1
  v_mov_b32 v7, 0
  v_dot2c_f32_bf16 v7, v100, v16
  v_dot2c_f32_bf16 v7, v101, v17
  v_dot2c_f32_bf16 v7, v102, v18
  v_dot2c_f32_bf16 v7, v103, v19
  v_dot2c_f32_bf16 v7, v104, v20
  v_dot2c_f32_bf16 v7, v105, v21
  v_dot2c_f32_bf16 v7, v106, v22
  v_dot2c_f32_bf16 v7, v107, v23
  v_dot2c_f32_bf16 v7, v108, v24
  v_dot2c_f32_bf16 v7, v109, v25
  v_dot2c_f32_bf16 v7, v110, v26
  v_dot2c_f32_bf16 v7, v111, v27
  s_nop 2
  v_add_f32_dpp v7, v7, v7 quad_perm:[1,0,3,2] row_mask:0xf bank_mask:0xf
  s_nop 1
  v_add_f32_dpp v7, v7, v7 quad_perm:[2,3,0,1] row_mask:0xf bank_mask:0xf
  s_nop 1
  v_add_f32_dpp v7, v7, v7 row_half_mirror row_mask:0xf bank_mask:0xf
  v_cndmask_b32 v28, v28, v7, vcc
  s_lshl_b64 vcc, vcc, 1
  v_mov_b32 v6, 0
  v_dot2c_f32_bf16 v6, v112, v16
  v_dot2c_f32_bf16 v6, v113, v17
  v_dot2c_f32_bf16 v6, v114, v18
  v_dot2c_f32_bf16 v6, v115, v19
  s_waitcnt vmcnt(4)
  buffer_load_dwordx4 v[72:75], v1, s[40:43], s74 offen offset:256 nt
  v_dot2c_f32_bf16 v6, v116, v20
  v_dot2c_f32_bf16 v6, v117, v21
  v_dot2c_f32_bf16 v6, v118, v22
  v_dot2c_f32_bf16 v6, v119, v23
  v_dot2c_f32_bf16 v6, v120, v24
  v_dot2c_f32_bf16 v6, v121, v25
  v_dot2c_f32_bf16 v6, v122, v26
  v_dot2c_f32_bf16 v6, v123, v27
  s_nop 2
  v_add_f32_dpp v6, v6, v6 quad_perm:[1,0,3,2] row_mask:0xf bank_mask:0xf
  s_nop 1
  v_add_f32_dpp v6, v6, v6 quad_perm:[2,3,0,1] row_mask:0xf bank_mask:0xf
  s_nop 1
  v_add_f32_dpp v6, v6, v6 row_half_mirror row_mask:0xf bank_mask:0xf
  v_cndmask_b32 v28, v28, v6, vcc
  s_lshl_b64 vcc, vcc, 1
  v_mov_b32 v7, 0
  v_dot2c_f32_bf16 v7, v124, v16
  v_dot2c_f32_bf16 v7, v125, v17
  v_dot2c_f32_bf16 v7, v126, v18
  v_dot2c_f32_bf16 v7, v127, v19
  v_dot2c_f32_bf16 v7, v128, v20
  v_dot2c_f32_bf16 v7, v129, v21
  v_dot2c_f32_bf16 v7, v130, v22
  v_dot2c_f32_bf16 v7, v131, v23
  v_dot2c_f32_bf16 v7, v132, v24
  v_dot2c_f32_bf16 v7, v133, v25
  v_dot2c_f32_bf16 v7, v134, v26
  v_dot2c_f32_bf16 v7, v135, v27
  s_nop 2
  v_add_f32_dpp v7, v7, v7 quad_perm:[1,0,3,2] row_mask:0xf bank_mask:0xf
  s_nop 1
  v_add_f32_dpp v7, v7, v7 quad_perm:[2,3,0,1] row_mask:0xf bank_mask:0xf
  s_nop 1
  v_add_f32_dpp v7, v7, v7 row_half_mirror row_mask:0xf bank_mask:0xf
  v_cndmask_b32 v28, v28, v7, vcc
  s_lshl_b64 vcc, vcc, 1
  s_waitcnt vmcnt(4)
  buffer_load_dwordx4 v[76:79], v1, s[40:43], s75 offen offset:0 nt
  v_mov_b32 v6, 0
  v_dot2c_f32_bf16 v6, v136, v16
  v_dot2c_f32_bf16 v6, v137, v17
  v_dot2c_f32_bf16 v6, v138, v18
  v_dot2c_f32_bf16 v6, v139, v19
  v_dot2c_f32_bf16 v6, v140, v20
  v_dot2c_f32_bf16 v6, v141, v21
  v_dot2c_f32_bf16 v6, v142, v22
  v_dot2c_f32_bf16 v6, v143, v23
  v_dot2c_f32_bf16 v6, v144, v24
  v_dot2c_f32_bf16 v6, v145, v25
  v_dot2c_f32_bf16 v6, v146, v26
  v_dot2c_f32_bf16 v6, v147, v27
  s_nop 2
  v_add_f32_dpp v6, v6, v6 quad_perm:[1,0,3,2] row_mask:0xf bank_mask:0xf
  s_nop 1
  v_add_f32_dpp v6, v6, v6 quad_perm:[2,3,0,1] row_mask:0xf bank_mask:0xf
  s_nop 1
  v_add_f32_dpp v6, v6, v6 row_half_mirror row_mask:0xf bank_mask:0xf
  v_cndmask_b32 v28, v28, v6, vcc
  s_lshl_b64 vcc, vcc, 1
  v_mov_b32 v7, 0
  v_dot2c_f32_bf16 v7, v148, v16
  v_dot2c_f32_bf16 v7, v149, v17
  v_dot2c_f32_bf16 v7, v150, v18
  v_dot2c_f32_bf16 v7, v151, v19
  ds_read_b128 v[16:19], v49 offset:0
  v_dot2c_f32_bf16 v7, v152, v20
  v_dot2c_f32_bf16 v7, v153, v21
  v_dot2c_f32_bf16 v7, v154, v22
  v_dot2c_f32_bf16 v7, v155, v23
  ds_read_b128 v[20:23], v49 offset:128
  v_dot2c_f32_bf16 v7, v156, v24
  v_dot2c_f32_bf16 v7, v157, v25
  v_dot2c_f32_bf16 v7, v158, v26
  v_dot2c_f32_bf16 v7, v159, v27
  ds_read_b128 v[24:27], v49 offset:256
  s_nop 2
  v_add_f32_dpp v7, v7, v7 quad_perm:[1,0,3,2] row_mask:0xf bank_mask:0xf
  s_nop 1
  v_add_f32_dpp v7, v7, v7 quad_perm:[2,3,0,1] row_mask:0xf bank_mask:0xf
  s_nop 1
  v_add_f32_dpp v7, v7, v7 row_half_mirror row_mask:0xf bank_mask:0xf
  v_cndmask_b32 v28, v28, v7, vcc
  s_lshl_b64 vcc, vcc, 1
  v_mov_b32 v35, v34
  v_mov_b32 v34, v33
  v_mov_b32 v33, v32
  v_mov_b32 v32, v31
  v_mov_b32 v31, v30
  v_mov_b32 v30, v29
  v_mov_b32 v29, v28
  v_add_u32 v49, 384, v49
  s_mov_b32 vcc_lo, 0x01010101
  s_mov_b32 vcc_hi, 0x01010101
  s_waitcnt lgkmcnt(0)
  s_waitcnt vmcnt(4)
  buffer_load_dwordx4 v[80:83], v1, s[40:43], s75 offen offset:128 nt
  v_mov_b32 v6, 0
  v_dot2c_f32_bf16 v6, v160, v16
  v_dot2c_f32_bf16 v6, v161, v17
  v_dot2c_f32_bf16 v6, v162, v18
  v_dot2c_f32_bf16 v6, v163, v19
  v_dot2c_f32_bf16 v6, v164, v20
  v_dot2c_f32_bf16 v6, v165, v21
  v_dot2c_f32_bf16 v6, v166, v22
  v_dot2c_f32_bf16 v6, v167, v23
  v_dot2c_f32_bf16 v6, v168, v24
  v_dot2c_f32_bf16 v6, v169, v25
  v_dot2c_f32_bf16 v6, v170, v26
  v_dot2c_f32_bf16 v6, v171, v27
  s_nop 2
  v_add_f32_dpp v6, v6, v6 quad_perm:[1,0,3,2] row_mask:0xf bank_mask:0xf
  s_nop 1
  v_add_f32_dpp v6, v6, v6 quad_perm:[2,3,0,1] row_mask:0xf bank_mask:0xf
  s_nop 1
  v_add_f32_dpp v6, v6, v6 row_half_mirror row_mask:0xf bank_mask:0xf
  v_cndmask_b32 v28, v28, v6, vcc
  s_lshl_b64 vcc, vcc, 1
  v_mov_b32 v7, 0
  v_dot2c_f32_bf16 v7, v172, v16
  v_dot2c_f32_bf16 v7, v173, v17
  v_dot2c_f32_bf16 v7, v174, v18
  v_dot2c_f32_bf16 v7, v175, v19
  v_dot2c_f32_bf16 v7, v176, v20
  v_dot2c_f32_bf16 v7, v177, v21
  v_dot2c_f32_bf16 v7, v178, v22
  v_dot2c_f32_bf16 v7, v179, v23
  s_waitcnt vmcnt(4)
  buffer_load_dwordx4 v[84:87], v1, s[40:43], s75 offen offset:256 nt
  v_dot2c_f32_bf16 v7, v180, v24
  v_dot2c_f32_bf16 v7, v181, v25
  v_dot2c_f32_bf16 v7, v182, v26
  v_dot2c_f32_bf16 v7, v183, v27
  s_nop 2
  v_add_f32_dpp v7, v7, v7 quad_perm:[1,0,3,2] row_mask:0xf bank_mask:0xf
  s_nop 1
  v_add_f32_dpp v7, v7, v7 quad_perm:[2,3,0,1] row_mask:0xf bank_mask:0xf
  s_nop 1
  v_add_f32_dpp v7, v7, v7 row_half_mirror row_mask:0xf bank_mask:0xf
  v_cndmask_b32 v28, v28, v7, vcc
  s_lshl_b64 vcc, vcc, 1
  v_mov_b32 v6, 0
  v_dot2c_f32_bf16 v6, v184, v16
  v_dot2c_f32_bf16 v6, v185, v17
  v_dot2c_f32_bf16 v6, v186, v18
  v_dot2c_f32_bf16 v6, v187, v19
  v_dot2c_f32_bf16 v6, v188, v20
  v_dot2c_f32_bf16 v6, v189, v21
  v_dot2c_f32_bf16 v6, v190, v22
  v_dot2c_f32_bf16 v6, v191, v23
  v_dot2c_f32_bf16 v6, v192, v24
  v_dot2c_f32_bf16 v6, v193, v25
  v_dot2c_f32_bf16 v6, v194, v26
  v_dot2c_f32_bf16 v6, v195, v27
  s_nop 2
  v_add_f32_dpp v6, v6, v6 quad_perm:[1,0,3,2] row_mask:0xf bank_mask:0xf
  s_nop 1
  v_add_f32_dpp v6, v6, v6 quad_perm:[2,3,0,1] row_mask:0xf bank_mask:0xf
  s_nop 1
  v_add_f32_dpp v6, v6, v6 row_half_mirror row_mask:0xf bank_mask:0xf
  v_cndmask_b32 v28, v28, v6, vcc
  s_lshl_b64 vcc, vcc, 1
  v_mov_b32 v7, 0
  v_dot2c_f32_bf16 v7, v196, v16
  v_dot2c_f32_bf16 v7, v197, v17
  v_dot2c_f32_bf16 v7, v198, v18
  v_dot2c_f32_bf16 v7, v199, v19
  s_waitcnt vmcnt(4)
  buffer_load_dwordx4 v[88:91], v1, s[40:43], s76 offen offset:0 nt
  v_dot2c_f32_bf16 v7, v200, v20
  v_dot2c_f32_bf16 v7, v201, v21
  v_dot2c_f32_bf16 v7, v202, v22
  v_dot2c_f32_bf16 v7, v203, v23
  v_dot2c_f32_bf16 v7, v204, v24
  v_dot2c_f32_bf16 v7, v205, v25
  v_dot2c_f32_bf16 v7, v206, v26
  v_dot2c_f32_bf16 v7, v207, v27
  s_nop 2
  v_add_f32_dpp v7, v7, v7 quad_perm:[1,0,3,2] row_mask:0xf bank_mask:0xf
  s_nop 1
  v_add_f32_dpp v7, v7, v7 quad_perm:[2,3,0,1] row_mask:0xf bank_mask:0xf
  s_nop 1
  v_add_f32_dpp v7, v7, v7 row_half_mirror row_mask:0xf bank_mask:0xf
  v_cndmask_b32 v28, v28, v7, vcc
  s_lshl_b64 vcc, vcc, 1
  v_mov_b32 v6, 0
  v_dot2c_f32_bf16 v6, v208, v16
  v_dot2c_f32_bf16 v6, v209, v17
  v_dot2c_f32_bf16 v6, v210, v18
  v_dot2c_f32_bf16 v6, v211, v19
  v_dot2c_f32_bf16 v6, v212, v20
  v_dot2c_f32_bf16 v6, v213, v21
  v_dot2c_f32_bf16 v6, v214, v22
  v_dot2c_f32_bf16 v6, v215, v23
  v_dot2c_f32_bf16 v6, v216, v24
  v_dot2c_f32_bf16 v6, v217, v25
  v_dot2c_f32_bf16 v6, v218, v26
  v_dot2c_f32_bf16 v6, v219, v27
  s_nop 2
  v_add_f32_dpp v6, v6, v6 quad_perm:[1,0,3,2] row_mask:0xf bank_mask:0xf
  s_nop 1
  v_add_f32_dpp v6, v6, v6 quad_perm:[2,3,0,1] row_mask:0xf bank_mask:0xf
  s_nop 1
  v_add_f32_dpp v6, v6, v6 row_half_mirror row_mask:0xf bank_mask:0xf
  v_cndmask_b32 v28, v28, v6, vcc
  s_lshl_b64 vcc, vcc, 1
  v_mov_b32 v7, 0
  v_dot2c_f32_bf16 v7, v220, v16
  v_dot2c_f32_bf16 v7, v221, v17
  v_dot2c_f32_bf16 v7, v222, v18
  v_dot2c_f32_bf16 v7, v223, v19
  s_waitcnt vmcnt(4)
  buffer_load_dwordx4 v[92:95], v1, s[40:43], s76 offen offset:128 nt
  v_dot2c_f32_bf16 v7, v224, v20
  v_dot2c_f32_bf16 v7, v225, v21
  v_dot2c_f32_bf16 v7, v226, v22
  v_dot2c_f32_bf16 v7, v227, v23
  v_dot2c_f32_bf16 v7, v228, v24
  v_dot2c_f32_bf16 v7, v229, v25
  v_dot2c_f32_bf16 v7, v230, v26
  v_dot2c_f32_bf16 v7, v231, v27
  s_nop 2
  v_add_f32_dpp v7, v7, v7 quad_perm:[1,0,3,2] row_mask:0xf bank_mask:0xf
  s_nop 1
  v_add_f32_dpp v7, v7, v7 quad_perm:[2,3,0,1] row_mask:0xf bank_mask:0xf
  s_nop 1
  v_add_f32_dpp v7, v7, v7 row_half_mirror row_mask:0xf bank_mask:0xf
  v_cndmask_b32 v28, v28, v7, vcc
  s_lshl_b64 vcc, vcc, 1
  v_mov_b32 v6, 0
  v_dot2c_f32_bf16 v6, v232, v16
  v_dot2c_f32_bf16 v6, v233, v17
  v_dot2c_f32_bf16 v6, v234, v18
  v_dot2c_f32_bf16 v6, v235, v19
  v_dot2c_f32_bf16 v6, v236, v20
  v_dot2c_f32_bf16 v6, v237, v21
  v_dot2c_f32_bf16 v6, v238, v22
  v_dot2c_f32_bf16 v6, v239, v23
  v_dot2c_f32_bf16 v6, v240, v24
  v_dot2c_f32_bf16 v6, v241, v25
  v_dot2c_f32_bf16 v6, v242, v26
  v_dot2c_f32_bf16 v6, v243, v27
  s_nop 2
  v_add_f32_dpp v6, v6, v6 quad_perm:[1,0,3,2] row_mask:0xf bank_mask:0xf
  s_nop 1
  v_add_f32_dpp v6, v6, v6 quad_perm:[2,3,0,1] row_mask:0xf bank_mask:0xf
  s_nop 1
  v_add_f32_dpp v6, v6, v6 row_half_mirror row_mask:0xf bank_mask:0xf
  v_cndmask_b32 v28, v28, v6, vcc
  s_lshl_b64 vcc, vcc, 1
  s_waitcnt vmcnt(4)
  buffer_load_dwordx4 v[96:99], v1, s[40:43], s76 offen offset:256 nt
  v_mov_b32 v7, 0
  v_dot2c_f32_bf16 v7, v244, v16
  v_dot2c_f32_bf16 v7, v245, v17
  v_dot2c_f32_bf16 v7, v246, v18
  v_dot2c_f32_bf16 v7, v247, v19
  ds_read_b128 v[16:19], v49 offset:0
  v_dot2c_f32_bf16 v7, v248, v20
  v_dot2c_f32_bf16 v7, v249, v21
  v_dot2c_f32_bf16 v7, v250, v22
  v_dot2c_f32_bf16 v7, v251, v23
  ds_read_b128 v[20:23], v49 offset:128
  v_dot2c_f32_bf16 v7, v252, v24
  v_dot2c_f32_bf16 v7, v253, v25
  v_dot2c_f32_bf16 v7, v254, v26
  v_dot2c_f32_bf16 v7, v255, v27
  ds_read_b128 v[24:27], v49 offset:256
  s_nop 2
  v_add_f32_dpp v7, v7, v7 quad_perm:[1,0,3,2] row_mask:0xf bank_mask:0xf
  s_nop 1
  v_add_f32_dpp v7, v7, v7 quad_perm:[2,3,0,1] row_mask:0xf bank_mask:0xf
  s_nop 1
  v_add_f32_dpp v7, v7, v7 row_half_mirror row_mask:0xf bank_mask:0xf
  v_cndmask_b32 v28, v28, v7, vcc
  s_lshl_b64 vcc, vcc, 1
  s_mov_b32 s14, 0
  s_memrealtime s[88:89]
  ds_read_b32 v42, v43 offset:3840
L_kloop:
  v_mov_b32 v35, v34
  v_mov_b32 v34, v33
  v_mov_b32 v33, v32
  v_mov_b32 v32, v31
  v_mov_b32 v31, v30
  v_mov_b32 v30, v29
  v_mov_b32 v29, v28
  v_add_u32 v49, 384, v49
  s_mov_b32 vcc_lo, 0x01010101
  s_mov_b32 vcc_hi, 0x01010101
  s_waitcnt lgkmcnt(0)
  v_readfirstlane_b32 s12, v42
  s_sub_u32 s11, s88, s90
  s_add_u32 s90, s90, 329
  s_add_u32 s92, s92, 1
  v_mov_b32 v44, s11
  v_mov_b32 v45, s92
  v_mov_b32 v46, s88
  ds_write_b96 v48, v[44:46] offset:3904
  s_cmp_eq_u32 s12, 0
  s_cselect_b32 s91, s91, s12
  s_sub_u32 s11, s11, s91
  s_cmp_lt_i32 s11, -30
  s_cbranch_scc1 L_ka_l0
  s_cmp_lt_i32 s11, 40
  s_cbranch_scc1 L_ka_l1
  s_cmp_lt_i32 s11, 140
  s_cbranch_scc1 L_ka_l2
L_ka_l3:
  s_waitcnt vmcnt(7)
  buffer_load_dwordx4 v[100:103], v1, s[40:43], s77 offen offset:0 nt
  v_mov_b32 v6, 0
  v_dot2c_f32_bf16 v6, v64, v16
  v_dot2c_f32_bf16 v6, v65, v17
  v_dot2c_f32_bf16 v6, v66, v18
  v_dot2c_f32_bf16 v6, v67, v19
  s_waitcnt vmcnt(7)
  buffer_load_dwordx4 v[104:107], v1, s[40:43], s77 offen offset:128 nt
  v_dot2c_f32_bf16 v6, v68, v20
  v_dot2c_f32_bf16 v6, v69, v21
  v_dot2c_f32_bf16 v6, v70, v22
  v_dot2c_f32_bf16 v6, v71, v23
  s_waitcnt vmcnt(7)
  buffer_load_dwordx4 v[108:111], v1, s[40:43], s77 offen offset:256 nt
  v_dot2c_f32_bf16 v6, v72, v24
  v_dot2c_f32_bf16 v6, v73, v25
  v_dot2c_f32_bf16 v6, v74, v26
  v_dot2c_f32_bf16 v6, v75, v27
  s_nop 2
  v_add_f32_dpp v6, v6, v6 quad_perm:[1,0,3,2] row_mask:0xf bank_mask:0xf
  s_nop 1
  v_add_f32_dpp v6, v6, v6 quad_perm:[2,3,0,1] row_mask:0xf bank_mask:0xf
  s_nop 1
  v_add_f32_dpp v6, v6, v6 row_half_mirror row_mask:0xf bank_mask:0xf
  v_cndmask_b32 v28, v28, v6, vcc
  s_lshl_b64 vcc, vcc, 1
  s_waitcnt vmcnt(7)
  buffer_load_dwordx4 v[112:115], v1, s[40:43], s78 offen offset:0 nt
  v_mov_b32 v7, 0
  v_dot2c_f32_bf16 v7, v76, v16
  v_dot2c_f32_bf16 v7, v77, v17
  v_dot2c_f32_bf16 v7, v78, v18
  v_dot2c_f32_bf16 v7, v79, v19
  s_waitcnt vmcnt(7)
  buffer_load_dwordx4 v[116:119], v1, s[40:43], s78 offen offset:128 nt
  v_dot2c_f32_bf16 v7, v80, v20
  v_dot2c_f32_bf16 v7, v81, v21
  v_dot2c_f32_bf16 v7, v82, v22
  v_dot2c_f32_bf16 v7, v83, v23
  s_waitcnt vmcnt(7)
  buffer_load_dwordx4 v[120:123], v1, s[40:43], s78 offen offset:256 nt
  v_dot2c_f32_bf16 v7, v84, v24
  v_dot2c_f32_bf16 v7, v85, v25
  v_dot2c_f32_bf16 v7, v86, v26
  v_dot2c_f32_bf16 v7, v87, v27
  s_nop 2
  v_add_f32_dpp v7, v7, v7 quad_perm:[1,0,3,2] row_mask:0xf bank_mask:0xf
  s_nop 1
  v_add_f32_dpp v7, v7, v7 quad_perm:[2,3,0,1] row_mask:0xf bank_mask:0xf
  s_nop 1
  v_add_f32_dpp v7, v7, v7 row_half_mirror row_mask:0xf bank_mask:0xf
  v_cndmask_b32 v28, v28, v7, vcc
  s_lshl_b64 vcc, vcc, 1
  s_waitcnt vmcnt(7)
  buffer_load_dwordx4 v[124:127], v1, s[40:43], s79 offen offset:0 nt
  v_mov_b32 v6, 0
  v_dot2c_f32_bf16 v6, v88, v16
  v_dot2c_f32_bf16 v6, v89, v17
  v_dot2c_f32_bf16 v6, v90, v18
  v_dot2c_f32_bf16 v6, v91, v19
  s_waitcnt vmcnt(7)
  buffer_load_dwordx4 v[128:131], v1, s[40:43], s79 offen offset:128 nt
  v_dot2c_f32_bf16 v6, v92, v20
  v_dot2c_f32_bf16 v6, v93, v21
  v_dot2c_f32_bf16 v6, v94, v22
  v_dot2c_f32_bf16 v6, v95, v23
  s_waitcnt vmcnt(7)
  buffer_load_dwordx4 v[132:135], v1, s[40:43], s79 offen offset:256 nt
  v_dot2c_f32_bf16 v6, v96, v24
  v_dot2c_f32_bf16 v6, v97, v25
  v_dot2c_f32_bf16 v6, v98, v26
  v_dot2c_f32_bf16 v6, v99, v27
  s_nop 2
  v_add_f32_dpp v6, v6, v6 quad_perm:[1,0,3,2] row_mask:0xf bank_mask:0xf
  s_nop 1
  v_add_f32_dpp v6, v6, v6 quad_perm:[2,3,0,1] row_mask:0xf bank_mask:0xf
  s_nop 1
  v_add_f32_dpp v6, v6, v6 row_half_mirror row_mask:0xf bank_mask:0xf
  v_cndmask_b32 v28, v28, v6, vcc
  s_lshl_b64 vcc, vcc, 1
  s_waitcnt vmcnt(7)
  buffer_load_dwordx4 v[136:139], v1, s[40:43], s80 offen offset:0 nt
  v_mov_b32 v7, 0
  v_dot2c_f32_bf16 v7, v100, v16
  v_dot2c_f32_bf16 v7, v101, v17
  v_dot2c_f32_bf16 v7, v102, v18
  v_dot2c_f32_bf16 v7, v103, v19
  s_waitcnt vmcnt(7)
  buffer_load_dwordx4 v[140:143], v1, s[40:43], s80 offen offset:128 nt
  v_dot2c_f32_bf16 v7, v104, v20
  v_dot2c_f32_bf16 v7, v105, v21
  v_dot2c_f32_bf16 v7, v106, v22
  v_dot2c_f32_bf16 v7, v107, v23
  s_waitcnt vmcnt(7)
  buffer_load_dwordx4 v[144:147], v1, s[40:43], s80 offen offset:256 nt
  s_memrealtime s[88:89]
  v_dot2c_f32_bf16 v7, v108, v24
  v_dot2c_f32_bf16 v7, v109, v25
  v_dot2c_f32_bf16 v7, v110, v26
  v_dot2c_f32_bf16 v7, v111, v27
  s_nop 2
  v_add_f32_dpp v7, v7, v7 quad_perm:[1,0,3,2] row_mask:0xf bank_mask:0xf
  s_nop 1
  v_add_f32_dpp v7, v7, v7 quad_perm:[2,3,0,1] row_mask:0xf bank_mask:0xf
  s_nop 1
  v_add_f32_dpp v7, v7, v7 row_half_mirror row_mask:0xf bank_mask:0xf
  v_cndmask_b32 v28, v28, v7, vcc
  s_lshl_b64 vcc, vcc, 1
  s_branch L_ka_join
L_ka_l2:
  s_waitcnt vmcnt(5)
  buffer_load_dwordx4 v[100:103], v1, s[40:43], s77 offen offset:0 nt
  v_mov_b32 v6, 0
  v_dot2c_f32_bf16 v6, v64, v16
  v_dot2c_f32_bf16 v6, v65, v17
  v_dot2c_f32_bf16 v6, v66, v18
  v_dot2c_f32_bf16 v6, v67, v19
  s_waitcnt vmcnt(5)
  buffer_load_dwordx4 v[104:107], v1, s[40:43], s77 offen offset:128 nt
  v_dot2c_f32_bf16 v6, v68, v20
  v_dot2c_f32_bf16 v6, v69, v21
  v_dot2c_f32_bf16 v6, v70, v22
  v_dot2c_f32_bf16 v6, v71, v23
  s_waitcnt vmcnt(5)
  buffer_load_dwordx4 v[108:111], v1, s[40:43], s77 offen offset:256 nt
  v_dot2c_f32_bf16 v6, v72, v24
  v_dot2c_f32_bf16 v6, v73, v25
  v_dot2c_f32_bf16 v6, v74, v26
  v_dot2c_f32_bf16 v6, v75, v27
  s_nop 2
  v_add_f32_dpp v6, v6, v6 quad_perm:[1,0,3,2] row_mask:0xf bank_mask:0xf
  s_nop 1
  v_add_f32_dpp v6, v6, v6 quad_perm:[2,3,0,1] row_mask:0xf bank_mask:0xf
  s_nop 1
  v_add_f32_dpp v6, v6, v6 row_half_mirror row_mask:0xf bank_mask:0xf
  v_cndmask_b32 v28, v28, v6, vcc
  s_lshl_b64 vcc, vcc, 1
  s_waitcnt vmcnt(5)
  buffer_load_dwordx4 v[112:115], v1, s[40:43], s78 offen offset:0 nt
  v_mov_b32 v7, 0
  v_dot2c_f32_bf16 v7, v76, v16
  v_dot2c_f32_bf16 v7, v77, v17
  v_dot2c_f32_bf16 v7, v78, v18
  v_dot2c_f32_bf16 v7, v79, v19
  s_waitcnt vmcnt(5)
  buffer_load_dwordx4 v[116:119], v1, s[40:43], s78 offen offset:128 nt
  v_dot2c_f32_bf16 v7, v80, v20
  v_dot2c_f32_bf16 v7, v81, v21
  v_dot2c_f32_bf16 v7, v82, v22
  v_dot2c_f32_bf16 v7, v83, v23
  s_waitcnt vmcnt(5)
  buffer_load_dwordx4 v[120:123], v1, s[40:43], s78 offen offset:256 nt
  v_dot2c_f32_bf16 v7, v84, v24
  v_dot2c_f32_bf16 v7, v85, v25
  v_dot2c_f32_bf16 v7, v86, v26
  v_dot2c_f32_bf16 v7, v87, v27
  s_nop 2
  v_add_f32_dpp v7, v7, v7 quad_perm:[1,0,3,2] row_mask:0xf bank_mask:0xf
  s_nop 1
  v_add_f32_dpp v7, v7, v7 quad_perm:[2,3,0,1] row_mask:0xf bank_mask:0xf
  s_nop 1
  v_add_f32_dpp v7, v7, v7 row_half_mirror row_mask:0xf bank_mask:0xf
  v_cndmask_b32 v28, v28, v7, vcc
  s_lshl_b64 vcc, vcc, 1
  s_waitcnt vmcnt(5)
  buffer_load_dwordx4 v[124:127], v1, s[40:43], s79 offen offset:0 nt
  v_mov_b32 v6, 0
  v_dot2c_f32_bf16 v6, v88, v16
  v_dot2c_f32_bf16 v6, v89, v17
  v_dot2c_f32_bf16 v6, v90, v18
  v_dot2c_f32_bf16 v6, v91, v19
  s_waitcnt vmcnt(5)
  buffer_load_dwordx4 v[128:131], v1, s[40:43], s79 offen offset:128 nt
  v_dot2c_f32_bf16 v6, v92, v20
  v_dot2c_f32_bf16 v6, v93, v21
  v_dot2c_f32_bf16 v6, v94, v22
  v_dot2c_f32_bf16 v6, v95, v23
  s_waitcnt vmcnt(5)
  buffer_load_dwordx4 v[132:135], v1, s[40:43], s79 offen offset:256 nt
  v_dot2c_f32_bf16 v6, v96, v24
  v_dot2c_f32_bf16 v6, v97, v25
  v_dot2c_f32_bf16 v6, v98, v26
  v_dot2c_f32_bf16 v6, v99, v27
  s_nop 2
  v_add_f32_dpp v6, v6, v6 quad_perm:[1,0,3,2] row_mask:0xf bank_mask:0xf
  s_nop 1
  v_add_f32_dpp v6, v6, v6 quad_perm:[2,3,0,1] row_mask:0xf bank_mask:0xf
  s_nop 1
  v_add_f32_dpp v6, v6, v6 row_half_mirror row_mask:0xf bank_mask:0xf
  v_cndmask_b32 v28, v28, v6, vcc
  s_lshl_b64 vcc, vcc, 1
  s_waitcnt vmcnt(5)
  buffer_load_dwordx4 v[136:139], v1, s[40:43], s80 offen offset:0 nt
  v_mov_b32 v7, 0
  v_dot2c_f32_bf16 v7, v100, v16
  v_dot2c_f32_bf16 v7, v101, v17
  v_dot2c_f32_bf16 v7, v102, v18
  v_dot2c_f32_bf16 v7, v103, v19
  s_waitcnt vmcnt(5)
  buffer_load_dwordx4 v[140:143], v1, s[40:43], s80 offen offset:128 nt
  v_dot2c_f32_bf16 v7, v104, v20
  v_dot2c_f32_bf16 v7, v105, v21
  v_dot2c_f32_bf16 v7, v106, v22
  v_dot2c_f32_bf16 v7, v107, v23
  s_waitcnt vmcnt(5)
  buffer_load_dwordx4 v[144:147], v1, s[40:43], s80 offen offset:256 nt
  s_memrealtime s[88:89]
  v_dot2c_f32_bf16 v7, v108, v24
  v_dot2c_f32_bf16 v7, v109, v25
  v_dot2c_f32_bf16 v7, v110, v26
  v_dot2c_f32_bf16 v7, v111, v27
  s_nop 2
  v_add_f32_dpp v7, v7, v7 quad_perm:[1,0,3,2] row_mask:0xf bank_mask:0xf
  s_nop 1
  v_add_f32_dpp v7, v7, v7 quad_perm:[2,3,0,1] row_mask:0xf bank_mask:0xf
  s_nop 1
  v_add_f32_dpp v7, v7, v7 row_half_mirror row_mask:0xf bank_mask:0xf
  v_cndmask_b32 v28, v28, v7, vcc
  s_lshl_b64 vcc, vcc, 1
  s_branch L_ka_join
L_ka_l1:
  s_waitcnt vmcnt(4)
  buffer_load_dwordx4 v[100:103], v1, s[40:43], s77 offen offset:0 nt
  v_mov_b32 v6, 0
  v_dot2c_f32_bf16 v6, v64, v16
  v_dot2c_f32_bf16 v6, v65, v17
  v_dot2c_f32_bf16 v6, v66, v18
  v_dot2c_f32_bf16 v6, v67, v19
  s_waitcnt vmcnt(4)
  buffer_load_dwordx4 v[104:107], v1, s[40:43], s77 offen offset:128 nt
  v_dot2c_f32_bf16 v6, v68, v20
  v_dot2c_f32_bf16 v6, v69, v21
  v_dot2c_f32_bf16 v6, v70, v22
  v_dot2c_f32_bf16 v6, v71, v23
  s_waitcnt vmcnt(4)
  buffer_load_dwordx4 v[108:111], v1, s[40:43], s77 offen offset:256 nt
  v_dot2c_f32_bf16 v6, v72, v24
  v_dot2c_f32_bf16 v6, v73, v25
  v_dot2c_f32_bf16 v6, v74, v26
  v_dot2c_f32_bf16 v6, v75, v27
  s_nop 2
  v_add_f32_dpp v6, v6, v6 quad_perm:[1,0,3,2] row_mask:0xf bank_mask:0xf
  s_nop 1
  v_add_f32_dpp v6, v6, v6 quad_perm:[2,3,0,1] row_mask:0xf bank_mask:0xf
  s_nop 1
  v_add_f32_dpp v6, v6, v6 row_half_mirror row_mask:0xf bank_mask:0xf
  v_cndmask_b32 v28, v28, v6, vcc
  s_lshl_b64 vcc, vcc, 1
  s_waitcnt vmcnt(4)
  buffer_load_dwordx4 v[112:115], v1, s[40:43], s78 offen offset:0 nt
  v_mov_b32 v7, 0
  v_dot2c_f32_bf16 v7, v76, v16
  v_dot2c_f32_bf16 v7, v77, v17
  v_dot2c_f32_bf16 v7, v78, v18
  v_dot2c_f32_bf16 v7, v79, v19
  s_waitcnt vmcnt(4)
  buffer_load_dwordx4 v[116:119], v1, s[40:43], s78 offen offset:128 nt
  v_dot2c_f32_bf16 v7, v80, v20
  v_dot2c_f32_bf16 v7, v81, v21
  v_dot2c_f32_bf16 v7, v82, v22
  v_dot2c_f32_bf16 v7, v83, v23
  s_waitcnt vmcnt(4)
  buffer_load_dwordx4 v[120:123], v1, s[40:43], s78 offen offset:256 nt
  v_dot2c_f32_bf16 v7, v84, v24
  v_dot2c_f32_bf16 v7, v85, v25
  v_dot2c_f32_bf16 v7, v86, v26
  v_dot2c_f32_bf16 v7, v87, v27
  s_nop 2
  v_add_f32_dpp v7, v7, v7 quad_perm:[1,0,3,2] row_mask:0xf bank_mask:0xf
  s_nop 1
  v_add_f32_dpp v7, v7, v7 quad_perm:[2,3,0,1] row_mask:0xf bank_mask:0xf
  s_nop 1
  v_add_f32_dpp v7, v7, v7 row_half_mirror row_mask:0xf bank_mask:0xf
  v_cndmask_b32 v28, v28, v7, vcc
  s_lshl_b64 vcc, vcc, 1
  s_waitcnt vmcnt(4)
  buffer_load_dwordx4 v[124:127], v1, s[40:43], s79 offen offset:0 nt
  v_mov_b32 v6, 0
  v_dot2c_f32_bf16 v6, v88, v16
  v_dot2c_f32_bf16 v6, v89, v17
  v_dot2c_f32_bf16 v6, v90, v18
  v_dot2c_f32_bf16 v6, v91, v19
  s_waitcnt vmcnt(4)
  buffer_load_dwordx4 v[128:131], v1, s[40:43], s79 offen offset:128 nt
  v_dot2c_f32_bf16 v6, v92, v20
  v_dot2c_f32_bf16 v6, v93, v21
  v_dot2c_f32_bf16 v6, v94, v22
  v_dot2c_f32_bf16 v6, v95, v23
  s_waitcnt vmcnt(4)
  buffer_load_dwordx4 v[132:135], v1, s[40:43], s79 offen offset:256 nt
  v_dot2c_f32_bf16 v6, v96, v24
  v_dot2c_f32_bf16 v6, v97, v25
  v_dot2c_f32_bf16 v6, v98, v26
  v_dot2c_f32_bf16 v6, v99, v27
  s_nop 2
  v_add_f32_dpp v6, v6, v6 quad_perm:[1,0,3,2] row_mask:0xf bank_mask:0xf
  s_nop 1
  v_add_f32_dpp v6, v6, v6 quad_perm:[2,3,0,1] row_mask:0xf bank_mask:0xf
  s_nop 1
  v_add_f32_dpp v6, v6, v6 row_half_mirror row_mask:0xf bank_mask:0xf
  v_cndmask_b32 v28, v28, v6, vcc
  s_lshl_b64 vcc, vcc, 1
  s_waitcnt vmcnt(4)
  buffer_load_dwordx4 v[136:139], v1, s[40:43], s80 offen offset:0 nt
  v_mov_b32 v7, 0
  v_dot2c_f32_bf16 v7, v100, v16
  v_dot2c_f32_bf16 v7, v101, v17
  v_dot2c_f32_bf16 v7, v102, v18
  v_dot2c_f32_bf16 v7, v103, v19
  s_waitcnt vmcnt(4)
  buffer_load_dwordx4 v[140:143], v1, s[40:43], s80 offen offset:128 nt
  v_dot2c_f32_bf16 v7, v104, v20
  v_dot2c_f32_bf16 v7, v105, v21
  v_dot2c_f32_bf16 v7, v106, v22
  v_dot2c_f32_bf16 v7, v107, v23
  s_waitcnt vmcnt(4)
  buffer_load_dwordx4 v[144:147], v1, s[40:43], s80 offen offset:256 nt
  s_memrealtime s[88:89]
  v_dot2c_f32_bf16 v7, v108, v24
  v_dot2c_f32_bf16 v7, v109, v25
  v_dot2c_f32_bf16 v7, v110, v26
  v_dot2c_f32_bf16 v7, v111, v27
  s_nop 2
  v_add_f32_dpp v7, v7, v7 quad_perm:[1,0,3,2] row_mask:0xf bank_mask:0xf
  s_nop 1
  v_add_f32_dpp v7, v7, v7 quad_perm:[2,3,0,1] row_mask:0xf bank_mask:0xf
  s_nop 1
  v_add_f32_dpp v7, v7, v7 row_half_mirror row_mask:0xf bank_mask:0xf
  v_cndmask_b32 v28, v28, v7, vcc
  s_lshl_b64 vcc, vcc, 1
  s_branch L_ka_join
L_ka_l0:
  s_waitcnt vmcnt(3)
  buffer_load_dwordx4 v[100:103], v1, s[40:43], s77 offen offset:0 nt
  v_mov_b32 v6, 0
  v_dot2c_f32_bf16 v6, v64, v16
  v_dot2c_f32_bf16 v6, v65, v17
  v_dot2c_f32_bf16 v6, v66, v18
  v_dot2c_f32_bf16 v6, v67, v19
  s_waitcnt vmcnt(3)
  buffer_load_dwordx4 v[104:107], v1, s[40:43], s77 offen offset:128 nt
  v_dot2c_f32_bf16 v6, v68, v20
  v_dot2c_f32_bf16 v6, v69, v21
  v_dot2c_f32_bf16 v6, v70, v22
  v_dot2c_f32_bf16 v6, v71, v23
  s_waitcnt vmcnt(3)
  buffer_load_dwordx4 v[108:111], v1, s[40:43], s77 offen offset:256 nt
  v_dot2c_f32_bf16 v6, v72, v24
  v_dot2c_f32_bf16 v6, v73, v25
  v_dot2c_f32_bf16 v6, v74, v26
  v_dot2c_f32_bf16 v6, v75, v27
  s_nop 2
  v_add_f32_dpp v6, v6, v6 quad_perm:[1,0,3,2] row_mask:0xf bank_mask:0xf
  s_nop 1
  v_add_f32_dpp v6, v6, v6 quad_perm:[2,3,0,1] row_mask:0xf bank_mask:0xf
  s_nop 1
  v_add_f32_dpp v6, v6, v6 row_half_mirror row_mask:0xf bank_mask:0xf
  v_cndmask_b32 v28, v28, v6, vcc
  s_lshl_b64 vcc, vcc, 1
  s_waitcnt vmcnt(3)
  buffer_load_dwordx4 v[112:115], v1, s[40:43], s78 offen offset:0 nt
  v_mov_b32 v7, 0
  v_dot2c_f32_bf16 v7, v76, v16
  v_dot2c_f32_bf16 v7, v77, v17
  v_dot2c_f32_bf16 v7, v78, v18
  v_dot2c_f32_bf16 v7, v79, v19
  s_waitcnt vmcnt(3)
  buffer_load_dwordx4 v[116:119], v1, s[40:43], s78 offen offset:128 nt
  v_dot2c_f32_bf16 v7, v80, v20
  v_dot2c_f32_bf16 v7, v81, v21
  v_dot2c_f32_bf16 v7, v82, v22
  v_dot2c_f32_bf16 v7, v83, v23
  s_waitcnt vmcnt(3)
  buffer_load_dwordx4 v[120:123], v1, s[40:43], s78 offen offset:256 nt
  v_dot2c_f32_bf16 v7, v84, v24
  v_dot2c_f32_bf16 v7, v85, v25
  v_dot2c_f32_bf16 v7, v86, v26
  v_dot2c_f32_bf16 v7, v87, v27
  s_nop 2
  v_add_f32_dpp v7, v7, v7 quad_perm:[1,0,3,2] row_mask:0xf bank_mask:0xf
  s_nop 1
  v_add_f32_dpp v7, v7, v7 quad_perm:[2,3,0,1] row_mask:0xf bank_mask:0xf
  s_nop 1
  v_add_f32_dpp v7, v7, v7 row_half_mirror row_mask:0xf bank_mask:0xf
  v_cndmask_b32 v28, v28, v7, vcc
  s_lshl_b64 vcc, vcc, 1
  s_waitcnt vmcnt(3)
  buffer_load_dwordx4 v[124:127], v1, s[40:43], s79 offen offset:0 nt
  v_mov_b32 v6, 0
  v_dot2c_f32_bf16 v6, v88, v16
  v_dot2c_f32_bf16 v6, v89, v17
  v_dot2c_f32_bf16 v6, v90, v18
  v_dot2c_f32_bf16 v6, v91, v19
  s_waitcnt vmcnt(3)
  buffer_load_dwordx4 v[128:131], v1, s[40:43], s79 offen offset:128 nt
  v_dot2c_f32_bf16 v6, v92, v20
  v_dot2c_f32_bf16 v6, v93, v21
  v_dot2c_f32_bf16 v6, v94, v22
  v_dot2c_f32_bf16 v6, v95, v23
  s_waitcnt vmcnt(3)
  buffer_load_dwordx4 v[132:135], v1, s[40:43], s79 offen offset:256 nt
  v_dot2c_f32_bf16 v6, v96, v24
  v_dot2c_f32_bf16 v6, v97, v25
  v_dot2c_f32_bf16 v6, v98, v26
  v_dot2c_f32_bf16 v6, v99, v27
  s_nop 2
  v_add_f32_dpp v6, v6, v6 quad_perm:[1,0,3,2] row_mask:0xf bank_mask:0xf
  s_nop 1
  v_add_f32_dpp v6, v6, v6 quad_perm:[2,3,0,1] row_mask:0xf bank_mask:0xf
  s_nop 1
  v_add_f32_dpp v6, v6, v6 row_half_mirror row_mask:0xf bank_mask:0xf
  v_cndmask_b32 v28, v28, v6, vcc
  s_lshl_b64 vcc, vcc, 1
  s_waitcnt vmcnt(3)
  buffer_load_dwordx4 v[136:139], v1, s[40:43], s80 offen offset:0 nt
  v_mov_b32 v7, 0
  v_dot2c_f32_bf16 v7, v100, v16
  v_dot2c_f32_bf16 v7, v101, v17
  v_dot2c_f32_bf16 v7, v102, v18
  v_dot2c_f32_bf16 v7, v103, v19
  s_waitcnt vmcnt(3)
  buffer_load_dwordx4 v[140:143], v1, s[40:43], s80 offen offset:128 nt
  v_dot2c_f32_bf16 v7, v104, v20
  v_dot2c_f32_bf16 v7, v105, v21
  v_dot2c_f32_bf16 v7, v106, v22
  v_dot2c_f32_bf16 v7, v107, v23
  s_waitcnt vmcnt(3)
  buffer_load_dwordx4 v[144:147], v1, s[40:43], s80 offen offset:256 nt
  s_memrealtime s[88:89]
  v_dot2c_f32_bf16 v7, v108, v24
  v_dot2c_f32_bf16 v7, v109, v25
  v_dot2c_f32_bf16 v7, v110, v26
  v_dot2c_f32_bf16 v7, v111, v27
  s_nop 2
  v_add_f32_dpp v7, v7, v7 quad_perm:[1,0,3,2] row_mask:0xf bank_mask:0xf
  s_nop 1
  v_add_f32_dpp v7, v7, v7 quad_perm:[2,3,0,1] row_mask:0xf bank_mask:0xf
  s_nop 1
  v_add_f32_dpp v7, v7, v7 row_half_mirror row_mask:0xf bank_mask:0xf
  v_cndmask_b32 v28, v28, v7, vcc
  s_lshl_b64 vcc, vcc, 1
L_ka_join:
  s_waitcnt lgkmcnt(0)
  s_sub_u32 s11, s88, s90
  s_sub_u32 s11, s11, s91
  s_add_u32 s11, s11, 164
  s_cmp_lt_i32 s11, -30
  s_cbranch_scc1 L_kb_l0
  s_cmp_lt_i32 s11, 40
  s_cbranch_scc1 L_kb_l1
  s_cmp_lt_i32 s11, 140
  s_cbranch_scc1 L_kb_l2
L_kb_l3:
  s_waitcnt vmcnt(7)
  buffer_load_dwordx4 v[148:151], v1, s[40:43], s81 offen offset:0 nt
  v_mov_b32 v6, 0
  v_dot2c_f32_bf16 v6, v112, v16
  v_dot2c_f32_bf16 v6, v113, v17
  v_dot2c_f32_bf16 v6, v114, v18
  v_dot2c_f32_bf16 v6, v115, v19
  s_waitcnt vmcnt(7)
  buffer_load_dwordx4 v[152:155], v1, s[40:43], s81 offen offset:128 nt
  v_dot2c_f32_bf16 v6, v116, v20
  v_dot2c_f32_bf16 v6, v117, v21
  v_dot2c_f32_bf16 v6, v118, v22
  v_dot2c_f32_bf16 v6, v119, v23
  s_waitcnt vmcnt(7)
  buffer_load_dwordx4 v[156:159], v1, s[40:43], s81 offen offset:256 nt
  v_dot2c_f32_bf16 v6, v120, v24
  v_dot2c_f32_bf16 v6, v121, v25
  v_dot2c_f32_bf16 v6, v122, v26
  v_dot2c_f32_bf16 v6, v123, v27
  s_nop 2
  v_add_f32_dpp v6, v6, v6 quad_perm:[1,0,3,2] row_mask:0xf bank_mask:0xf
  s_nop 1
  v_add_f32_dpp v6, v6, v6 quad_perm:[2,3,0,1] row_mask:0xf bank_mask:0xf
  s_nop 1
  v_add_f32_dpp v6, v6, v6 row_half_mirror row_mask:0xf bank_mask:0xf
  v_cndmask_b32 v28, v28, v6, vcc
  s_lshl_b64 vcc, vcc, 1
  s_cmp_eq_u32 s14, 5
  s_cselect_b32 s40, s20, s40
  s_cselect_b32 s41, s21, s41
  s_add_u32 s40, s40, 25165824
  s_addc_u32 s41, s41, 0
  s_waitcnt vmcnt(7)
  buffer_load_dwordx4 v[64:67], v1, s[40:43], s74 offen offset:0 nt
  v_mov_b32 v7, 0
  v_dot2c_f32_bf16 v7, v124, v16
  v_dot2c_f32_bf16 v7, v125, v17
  v_dot2c_f32_bf16 v7, v126, v18
  v_dot2c_f32_bf16 v7, v127, v19
  s_waitcnt vmcnt(7)
  buffer_load_dwordx4 v[68:71], v1, s[40:43], s74 offen offset:128 nt
  v_dot2c_f32_bf16 v7, v128, v20
  v_dot2c_f32_bf16 v7, v129, v21
  v_dot2c_f32_bf16 v7, v130, v22
  v_dot2c_f32_bf16 v7, v131, v23
  s_waitcnt vmcnt(7)
  buffer_load_dwordx4 v[72:75], v1, s[40:43], s74 offen offset:256 nt
  v_dot2c_f32_bf16 v7, v132, v24
  v_dot2c_f32_bf16 v7, v133, v25
  v_dot2c_f32_bf16 v7, v134, v26
  v_dot2c_f32_bf16 v7, v135, v27
  s_nop 2
  v_add_f32_dpp v7, v7, v7 quad_perm:[1,0,3,2] row_mask:0xf bank_mask:0xf
  s_nop 1
  v_add_f32_dpp v7, v7, v7 quad_perm:[2,3,0,1] row_mask:0xf bank_mask:0xf
  s_nop 1
  v_add_f32_dpp v7, v7, v7 row_half_mirror row_mask:0xf bank_mask:0xf
  v_cndmask_b32 v28, v28, v7, vcc
  s_lshl_b64 vcc, vcc, 1
  s_waitcnt vmcnt(7)
  buffer_load_dwordx4 v[76:79], v1, s[40:43], s75 offen offset:0 nt
  v_mov_b32 v6, 0
  v_dot2c_f32_bf16 v6, v136, v16
  v_dot2c_f32_bf16 v6, v137, v17
  v_dot2c_f32_bf16 v6, v138, v18
  v_dot2c_f32_bf16 v6, v139, v19
  s_waitcnt vmcnt(7)
  buffer_load_dwordx4 v[80:83], v1, s[40:43], s75 offen offset:128 nt
  v_dot2c_f32_bf16 v6, v140, v20
  v_dot2c_f32_bf16 v6, v141, v21
  v_dot2c_f32_bf16 v6, v142, v22
  v_dot2c_f32_bf16 v6, v143, v23
  s_waitcnt vmcnt(7)
  buffer_load_dwordx4 v[84:87], v1, s[40:43], s75 offen offset:256 nt
  v_dot2c_f32_bf16 v6, v144, v24
  v_dot2c_f32_bf16 v6, v145, v25
  v_dot2c_f32_bf16 v6, v146, v26
  v_dot2c_f32_bf16 v6, v147, v27
  s_nop 2
  v_add_f32_dpp v6, v6, v6 quad_perm:[1,0,3,2] row_mask:0xf bank_mask:0xf
  s_nop 1
  v_add_f32_dpp v6, v6, v6 quad_perm:[2,3,0,1] row_mask:0xf bank_mask:0xf
  s_nop 1
  v_add_f32_dpp v6, v6, v6 row_half_mirror row_mask:0xf bank_mask:0xf
  v_cndmask_b32 v28, v28, v6, vcc
  s_lshl_b64 vcc, vcc, 1
  s_waitcnt vmcnt(7)
  buffer_load_dwordx4 v[88:91], v1, s[40:43], s76 offen offset:0 nt
  v_mov_b32 v7, 0
  v_dot2c_f32_bf16 v7, v148, v16
  v_dot2c_f32_bf16 v7, v149, v17
  v_dot2c_f32_bf16 v7, v150, v18
  v_dot2c_f32_bf16 v7, v151, v19
  ds_read_b128 v[16:19], v49 offset:0
  s_waitcnt vmcnt(7)
  buffer_load_dwordx4 v[92:95], v1, s[40:43], s76 offen offset:128 nt
  v_dot2c_f32_bf16 v7, v152, v20
  v_dot2c_f32_bf16 v7, v153, v21
  v_dot2c_f32_bf16 v7, v154, v22
  v_dot2c_f32_bf16 v7, v155, v23
  ds_read_b128 v[20:23], v49 offset:128
  s_waitcnt vmcnt(7)
  buffer_load_dwordx4 v[96:99], v1, s[40:43], s76 offen offset:256 nt
  s_memrealtime s[88:89]
  ds_read_b32 v42, v43 offset:3840
  v_dot2c_f32_bf16 v7, v156, v24
  v_dot2c_f32_bf16 v7, v157, v25
  v_dot2c_f32_bf16 v7, v158, v26
  v_dot2c_f32_bf16 v7, v159, v27
  ds_read_b128 v[24:27], v49 offset:256
  s_nop 2
  v_add_f32_dpp v7, v7, v7 quad_perm:[1,0,3,2] row_mask:0xf bank_mask:0xf
  s_nop 1
  v_add_f32_dpp v7, v7, v7 quad_perm:[2,3,0,1] row_mask:0xf bank_mask:0xf
  s_nop 1
  v_add_f32_dpp v7, v7, v7 row_half_mirror row_mask:0xf bank_mask:0xf
  v_cndmask_b32 v28, v28, v7, vcc
  s_lshl_b64 vcc, vcc, 1
  s_branch L_kb_join
L_kb_l2:
  s_waitcnt vmcnt(5)
  buffer_load_dwordx4 v[148:151], v1, s[40:43], s81 offen offset:0 nt
  v_mov_b32 v6, 0
  v_dot2c_f32_bf16 v6, v112, v16
  v_dot2c_f32_bf16 v6, v113, v17
  v_dot2c_f32_bf16 v6, v114, v18
  v_dot2c_f32_bf16 v6, v115, v19
  s_waitcnt vmcnt(5)
  buffer_load_dwordx4 v[152:155], v1, s[40:43], s81 offen offset:128 nt
  v_dot2c_f32_bf16 v6, v116, v20
  v_dot2c_f32_bf16 v6, v117, v21
  v_dot2c_f32_bf16 v6, v118, v22
  v_dot2c_f32_bf16 v6, v119, v23
  s_waitcnt vmcnt(5)
  buffer_load_dwordx4 v[156:159], v1, s[40:43], s81 offen offset:256 nt
  v_dot2c_f32_bf16 v6, v120, v24
  v_dot2c_f32_bf16 v6, v121, v25
  v_dot2c_f32_bf16 v6, v122, v26
  v_dot2c_f32_bf16 v6, v123, v27
  s_nop 2
  v_add_f32_dpp v6, v6, v6 quad_perm:[1,0,3,2] row_mask:0xf bank_mask:0xf
  s_nop 1
  v_add_f32_dpp v6, v6, v6 quad_perm:[2,3,0,1] row_mask:0xf bank_mask:0xf
  s_nop 1
  v_add_f32_dpp v6, v6, v6 row_half_mirror row_mask:0xf bank_mask:0xf
  v_cndmask_b32 v28, v28, v6, vcc
  s_lshl_b64 vcc, vcc, 1
  s_cmp_eq_u32 s14, 5
  s_cselect_b32 s40, s20, s40
  s_cselect_b32 s41, s21, s41
  s_add_u32 s40, s40, 25165824
  s_addc_u32 s41, s41, 0
  s_waitcnt vmcnt(5)
  buffer_load_dwordx4 v[64:67], v1, s[40:43], s74 offen offset:0 nt
  v_mov_b32 v7, 0
  v_dot2c_f32_bf16 v7, v124, v16
  v_dot2c_f32_bf16 v7, v125, v17
  v_dot2c_f32_bf16 v7, v126, v18
  v_dot2c_f32_bf16 v7, v127, v19
  s_waitcnt vmcnt(5)
  buffer_load_dwordx4 v[68:71], v1, s[40:43], s74 offen offset:128 nt
  v_dot2c_f32_bf16 v7, v128, v20
  v_dot2c_f32_bf16 v7, v129, v21
  v_dot2c_f32_bf16 v7, v130, v22
  v_dot2c_f32_bf16 v7, v131, v23
  s_waitcnt vmcnt(5)
  buffer_load_dwordx4 v[72:75], v1, s[40:43], s74 offen offset:256 nt
  v_dot2c_f32_bf16 v7, v132, v24
  v_dot2c_f32_bf16 v7, v133, v25
  v_dot2c_f32_bf16 v7, v134, v26
  v_dot2c_f32_bf16 v7, v135, v27
  s_nop 2
  v_add_f32_dpp v7, v7, v7 quad_perm:[1,0,3,2] row_mask:0xf bank_mask:0xf
  s_nop 1
  v_add_f32_dpp v7, v7, v7 quad_perm:[2,3,0,1] row_mask:0xf bank_mask:0xf
  s_nop 1
  v_add_f32_dpp v7, v7, v7 row_half_mirror row_mask:0xf bank_mask:0xf
  v_cndmask_b32 v28, v28, v7, vcc
  s_lshl_b64 vcc, vcc, 1
  s_waitcnt vmcnt(5)
  buffer_load_dwordx4 v[76:79], v1, s[40:43], s75 offen offset:0 nt
  v_mov_b32 v6, 0
  v_dot2c_f32_bf16 v6, v136, v16
  v_dot2c_f32_bf16 v6, v137, v17
  v_dot2c_f32_bf16 v6, v138, v18
  v_dot2c_f32_bf16 v6, v139, v19
  s_waitcnt vmcnt(5)
  buffer_load_dwordx4 v[80:83], v1, s[40:43], s75 offen offset:128 nt
  v_dot2c_f32_bf16 v6, v140, v20
  v_dot2c_f32_bf16 v6, v141, v21
  v_dot2c_f32_bf16 v6, v142, v22
  v_dot2c_f32_bf16 v6, v143, v23
  s_waitcnt vmcnt(5)
  buffer_load_dwordx4 v[84:87], v1, s[40:43], s75 offen offset:256 nt
  v_dot2c_f32_bf16 v6, v144, v24
  v_dot2c_f32_bf16 v6, v145, v25
  v_dot2c_f32_bf16 v6, v146, v26
  v_dot2c_f32_bf16 v6, v147, v27
  s_nop 2
  v_add_f32_dpp v6, v6, v6 quad_perm:[1,0,3,2] row_mask:0xf bank_mask:0xf
  s_nop 1
  v_add_f32_dpp v6, v6, v6 quad_perm:[2,3,0,1] row_mask:0xf bank_mask:0xf
  s_nop 1
  v_add_f32_dpp v6, v6, v6 row_half_mirror row_mask:0xf bank_mask:0xf
  v_cndmask_b32 v28, v28, v6, vcc
  s_lshl_b64 vcc, vcc, 1
  s_waitcnt vmcnt(5)
  buffer_load_dwordx4 v[88:91], v1, s[40:43], s76 offen offset:0 nt
  v_mov_b32 v7, 0
  v_dot2c_f32_bf16 v7, v148, v16
  v_dot2c_f32_bf16 v7, v149, v17
  v_dot2c_f32_bf16 v7, v150, v18
  v_dot2c_f32_bf16 v7, v151, v19
  ds_read_b128 v[16:19], v49 offset:0
  s_waitcnt vmcnt(5)
  buffer_load_dwordx4 v[92:95], v1, s[40:43], s76 offen offset:128 nt
  v_dot2c_f32_bf16 v7, v152, v20
  v_dot2c_f32_bf16 v7, v153, v21
  v_dot2c_f32_bf16 v7, v154, v22
  v_dot2c_f32_bf16 v7, v155, v23
  ds_read_b128 v[20:23], v49 offset:128
  s_waitcnt vmcnt(5)
  buffer_load_dwordx4 v[96:99], v1, s[40:43], s76 offen offset:256 nt
  s_memrealtime s[88:89]
  ds_read_b32 v42, v43 offset:3840
  v_dot2c_f32_bf16 v7, v156, v24
  v_dot2c_f32_bf16 v7, v157, v25
  v_dot2c_f32_bf16 v7, v158, v26
  v_dot2c_f32_bf16 v7, v159, v27
  ds_read_b128 v[24:27], v49 offset:256
  s_nop 2
  v_add_f32_dpp v7, v7, v7 quad_perm:[1,0,3,2] row_mask:0xf bank_mask:0xf
  s_nop 1
  v_add_f32_dpp v7, v7, v7 quad_perm:[2,3,0,1] row_mask:0xf bank_mask:0xf
  s_nop 1
  v_add_f32_dpp v7, v7, v7 row_half_mirror row_mask:0xf bank_mask:0xf
  v_cndmask_b32 v28, v28, v7, vcc
  s_lshl_b64 vcc, vcc, 1
  s_branch L_kb_join
L_kb_l1:
  s_waitcnt vmcnt(4)
  buffer_load_dwordx4 v[148:151], v1, s[40:43], s81 offen offset:0 nt
  v_mov_b32 v6, 0
  v_dot2c_f32_bf16 v6, v112, v16
  v_dot2c_f32_bf16 v6, v113, v17
  v_dot2c_f32_bf16 v6, v114, v18
  v_dot2c_f32_bf16 v6, v115, v19
  s_waitcnt vmcnt(4)
  buffer_load_dwordx4 v[152:155], v1, s[40:43], s81 offen offset:128 nt
  v_dot2c_f32_bf16 v6, v116, v20
  v_dot2c_f32_bf16 v6, v117, v21
  v_dot2c_f32_bf16 v6, v118, v22
  v_dot2c_f32_bf16 v6, v119, v23
  s_waitcnt vmcnt(4)
  buffer_load_dwordx4 v[156:159], v1, s[40:43], s81 offen offset:256 nt
  v_dot2c_f32_bf16 v6, v120, v24
  v_dot2c_f32_bf16 v6, v121, v25
  v_dot2c_f32_bf16 v6, v122, v26
  v_dot2c_f32_bf16 v6, v123, v27
  s_nop 2
  v_add_f32_dpp v6, v6, v6 quad_perm:[1,0,3,2] row_mask:0xf bank_mask:0xf
  s_nop 1
  v_add_f32_dpp v6, v6, v6 quad_perm:[2,3,0,1] row_mask:0xf bank_mask:0xf
  s_nop 1
  v_add_f32_dpp v6, v6, v6 row_half_mirror row_mask:0xf bank_mask:0xf
  v_cndmask_b32 v28, v28, v6, vcc
  s_lshl_b64 vcc, vcc, 1
  s_cmp_eq_u32 s14, 5
  s_cselect_b32 s40, s20, s40
  s_cselect_b32 s41, s21, s41
  s_add_u32 s40, s40, 25165824
  s_addc_u32 s41, s41, 0
  s_waitcnt vmcnt(4)
  buffer_load_dwordx4 v[64:67], v1, s[40:43], s74 offen offset:0 nt
  v_mov_b32 v7, 0
  v_dot2c_f32_bf16 v7, v124, v16
  v_dot2c_f32_bf16 v7, v125, v17
  v_dot2c_f32_bf16 v7, v126, v18
  v_dot2c_f32_bf16 v7, v127, v19
  s_waitcnt vmcnt(4)
  buffer_load_dwordx4 v[68:71], v1, s[40:43], s74 offen offset:128 nt
  v_dot2c_f32_bf16 v7, v128, v20
  v_dot2c_f32_bf16 v7, v129, v21
  v_dot2c_f32_bf16 v7, v130, v22
  v_dot2c_f32_bf16 v7, v131, v23
  s_waitcnt vmcnt(4)
  buffer_load_dwordx4 v[72:75], v1, s[40:43], s74 offen offset:256 nt
  v_dot2c_f32_bf16 v7, v132, v24
  v_dot2c_f32_bf16 v7, v133, v25
  v_dot2c_f32_bf16 v7, v134, v26
  v_dot2c_f32_bf16 v7, v135, v27
  s_nop 2
  v_add_f32_dpp v7, v7, v7 quad_perm:[1,0,3,2] row_mask:0xf bank_mask:0xf
  s_nop 1
  v_add_f32_dpp v7, v7, v7 quad_perm:[2,3,0,1] row_mask:0xf bank_mask:0xf
  s_nop 1
  v_add_f32_dpp v7, v7, v7 row_half_mirror row_mask:0xf bank_mask:0xf
  v_cndmask_b32 v28, v28, v7, vcc
  s_lshl_b64 vcc, vcc, 1
  s_waitcnt vmcnt(4)
  buffer_load_dwordx4 v[76:79], v1, s[40:43], s75 offen offset:0 nt
  v_mov_b32 v6, 0
  v_dot2c_f32_bf16 v6, v136, v16
  v_dot2c_f32_bf16 v6, v137, v17
  v_dot2c_f32_bf16 v6, v138, v18
  v_dot2c_f32_bf16 v6, v139, v19
  s_waitcnt vmcnt(4)
  buffer_load_dwordx4 v[80:83], v1, s[40:43], s75 offen offset:128 nt
  v_dot2c_f32_bf16 v6, v140, v20
  v_dot2c_f32_bf16 v6, v141, v21
  v_dot2c_f32_bf16 v6, v142, v22
  v_dot2c_f32_bf16 v6, v143, v23
  s_waitcnt vmcnt(4)
  buffer_load_dwordx4 v[84:87], v1, s[40:43], s75 offen offset:256 nt
  v_dot2c_f32_bf16 v6, v144, v24
  v_dot2c_f32_bf16 v6, v145, v25
  v_dot2c_f32_bf16 v6, v146, v26
  v_dot2c_f32_bf16 v6, v147, v27
  s_nop 2
  v_add_f32_dpp v6, v6, v6 quad_perm:[1,0,3,2] row_mask:0xf bank_mask:0xf
  s_nop 1
  v_add_f32_dpp v6, v6, v6 quad_perm:[2,3,0,1] row_mask:0xf bank_mask:0xf
  s_nop 1
  v_add_f32_dpp v6, v6, v6 row_half_mirror row_mask:0xf bank_mask:0xf
  v_cndmask_b32 v28, v28, v6, vcc
  s_lshl_b64 vcc, vcc, 1
  s_waitcnt vmcnt(4)
  buffer_load_dwordx4 v[88:91], v1, s[40:43], s76 offen offset:0 nt
  v_mov_b32 v7, 0
  v_dot2c_f32_bf16 v7, v148, v16
  v_dot2c_f32_bf16 v7, v149, v17
  v_dot2c_f32_bf16 v7, v150, v18
  v_dot2c_f32_bf16 v7, v151, v19
  ds_read_b128 v[16:19], v49 offset:0
  s_waitcnt vmcnt(4)
  buffer_load_dwordx4 v[92:95], v1, s[40:43], s76 offen offset:128 nt
  v_dot2c_f32_bf16 v7, v152, v20
  v_dot2c_f32_bf16 v7, v153, v21
  v_dot2c_f32_bf16 v7, v154, v22
  v_dot2c_f32_bf16 v7, v155, v23
  ds_read_b128 v[20:23], v49 offset:128
  s_waitcnt vmcnt(4)
  buffer_load_dwordx4 v[96:99], v1, s[40:43], s76 offen offset:256 nt
  s_memrealtime s[88:89]
  ds_read_b32 v42, v43 offset:3840
  v_dot2c_f32_bf16 v7, v156, v24
  v_dot2c_f32_bf16 v7, v157, v25
  v_dot2c_f32_bf16 v7, v158, v26
  v_dot2c_f32_bf16 v7, v159, v27
  ds_read_b128 v[24:27], v49 offset:256
  s_nop 2
  v_add_f32_dpp v7, v7, v7 quad_perm:[1,0,3,2] row_mask:0xf bank_mask:0xf
  s_nop 1
  v_add_f32_dpp v7, v7, v7 quad_perm:[2,3,0,1] row_mask:0xf bank_mask:0xf
  s_nop 1
  v_add_f32_dpp v7, v7, v7 row_half_mirror row_mask:0xf bank_mask:0xf
  v_cndmask_b32 v28, v28, v7, vcc
  s_lshl_b64 vcc, vcc, 1
  s_branch L_kb_join
L_kb_l0:
  s_waitcnt vmcnt(3)
  buffer_load_dwordx4 v[148:151], v1, s[40:43], s81 offen offset:0 nt
  v_mov_b32 v6, 0
  v_dot2c_f32_bf16 v6, v112, v16
  v_dot2c_f32_bf16 v6, v113, v17
  v_dot2c_f32_bf16 v6, v114, v18
  v_dot2c_f32_bf16 v6, v115, v19
  s_waitcnt vmcnt(3)
  buffer_load_dwordx4 v[152:155], v1, s[40:43], s81 offen offset:128 nt
  v_dot2c_f32_bf16 v6, v116, v20
  v_dot2c_f32_bf16 v6, v117, v21
  v_dot2c_f32_bf16 v6, v118, v22
  v_dot2c_f32_bf16 v6, v119, v23
  s_waitcnt vmcnt(3)
  buffer_load_dwordx4 v[156:159], v1, s[40:43], s81 offen offset:256 nt
  v_dot2c_f32_bf16 v6, v120, v24
  v_dot2c_f32_bf16 v6, v121, v25
  v_dot2c_f32_bf16 v6, v122, v26
  v_dot2c_f32_bf16 v6, v123, v27
  s_nop 2
  v_add_f32_dpp v6, v6, v6 quad_perm:[1,0,3,2] row_mask:0xf bank_mask:0xf
  s_nop 1
  v_add_f32_dpp v6, v6, v6 quad_perm:[2,3,0,1] row_mask:0xf bank_mask:0xf
  s_nop 1
  v_add_f32_dpp v6, v6, v6 row_half_mirror row_mask:0xf bank_mask:0xf
  v_cndmask_b32 v28, v28, v6, vcc
  s_lshl_b64 vcc, vcc, 1
  s_cmp_eq_u32 s14, 5
  s_cselect_b32 s40, s20, s40
  s_cselect_b32 s41, s21, s41
  s_add_u32 s40, s40, 25165824
  s_addc_u32 s41, s41, 0
  s_waitcnt vmcnt(3)
  buffer_load_dwordx4 v[64:67], v1, s[40:43], s74 offen offset:0 nt
  v_mov_b32 v7, 0
  v_dot2c_f32_bf16 v7, v124, v16
  v_dot2c_f32_bf16 v7, v125, v17
  v_dot2c_f32_bf16 v7, v126, v18
  v_dot2c_f32_bf16 v7, v127, v19
  s_waitcnt vmcnt(3)
  buffer_load_dwordx4 v[68:71], v1, s[40:43], s74 offen offset:128 nt
  v_dot2c_f32_bf16 v7, v128, v20
  v_dot2c_f32_bf16 v7, v129, v21
  v_dot2c_f32_bf16 v7, v130, v22
  v_dot2c_f32_bf16 v7, v131, v23
  s_waitcnt vmcnt(3)
  buffer_load_dwordx4 v[72:75], v1, s[40:43], s74 offen offset:256 nt
  v_dot2c_f32_bf16 v7, v132, v24
  v_dot2c_f32_bf16 v7, v133, v25
  v_dot2c_f32_bf16 v7, v134, v26
  v_dot2c_f32_bf16 v7, v135, v27
  s_nop 2
  v_add_f32_dpp v7, v7, v7 quad_perm:[1,0,3,2] row_mask:0xf bank_mask:0xf
  s_nop 1
  v_add_f32_dpp v7, v7, v7 quad_perm:[2,3,0,1] row_mask:0xf bank_mask:0xf
  s_nop 1
  v_add_f32_dpp v7, v7, v7 row_half_mirror row_mask:0xf bank_mask:0xf
  v_cndmask_b32 v28, v28, v7, vcc
  s_lshl_b64 vcc, vcc, 1
  s_waitcnt vmcnt(3)
  buffer_load_dwordx4 v[76:79], v1, s[40:43], s75 offen offset:0 nt
  v_mov_b32 v6, 0
  v_dot2c_f32_bf16 v6, v136, v16
  v_dot2c_f32_bf16 v6, v137, v17
  v_dot2c_f32_bf16 v6, v138, v18
  v_dot2c_f32_bf16 v6, v139, v19
  s_waitcnt vmcnt(3)
  buffer_load_dwordx4 v[80:83], v1, s[40:43], s75 offen offset:128 nt
  v_dot2c_f32_bf16 v6, v140, v20
  v_dot2c_f32_bf16 v6, v141, v21
  v_dot2c_f32_bf16 v6, v142, v22
  v_dot2c_f32_bf16 v6, v143, v23
  s_waitcnt vmcnt(3)
  buffer_load_dwordx4 v[84:87], v1, s[40:43], s75 offen offset:256 nt
  v_dot2c_f32_bf16 v6, v144, v24
  v_dot2c_f32_bf16 v6, v145, v25
  v_dot2c_f32_bf16 v6, v146, v26
  v_dot2c_f32_bf16 v6, v147, v27
  s_nop 2
  v_add_f32_dpp v6, v6, v6 quad_perm:[1,0,3,2] row_mask:0xf bank_mask:0xf
  s_nop 1
  v_add_f32_dpp v6, v6, v6 quad_perm:[2,3,0,1] row_mask:0xf bank_mask:0xf
  s_nop 1
  v_add_f32_dpp v6, v6, v6 row_half_mirror row_mask:0xf bank_mask:0xf
  v_cndmask_b32 v28, v28, v6, vcc
  s_lshl_b64 vcc, vcc, 1
  s_waitcnt vmcnt(3)
  buffer_load_dwordx4 v[88:91], v1, s[40:43], s76 offen offset:0 nt
  v_mov_b32 v7, 0
  v_dot2c_f32_bf16 v7, v148, v16
  v_dot2c_f32_bf16 v7, v149, v17
  v_dot2c_f32_bf16 v7, v150, v18
  v_dot2c_f32_bf16 v7, v151, v19
  ds_read_b128 v[16:19], v49 offset:0
  s_waitcnt vmcnt(3)
  buffer_load_dwordx4 v[92:95], v1, s[40:43], s76 offen offset:128 nt
  v_dot2c_f32_bf16 v7, v152, v20
  v_dot2c_f32_bf16 v7, v153, v21
  v_dot2c_f32_bf16 v7, v154, v22
  v_dot2c_f32_bf16 v7, v155, v23
  ds_read_b128 v[20:23], v49 offset:128
  s_waitcnt vmcnt(3)
  buffer_load_dwordx4 v[96:99], v1, s[40:43], s76 offen offset:256 nt
  s_memrealtime s[88:89]
  ds_read_b32 v42, v43 offset:3840
  v_dot2c_f32_bf16 v7, v156, v24
  v_dot2c_f32_bf16 v7, v157, v25
  v_dot2c_f32_bf16 v7, v158, v26
  v_dot2c_f32_bf16 v7, v159, v27
  ds_read_b128 v[24:27], v49 offset:256
  s_nop 2
  v_add_f32_dpp v7, v7, v7 quad_perm:[1,0,3,2] row_mask:0xf bank_mask:0xf
  s_nop 1
  v_add_f32_dpp v7, v7, v7 quad_perm:[2,3,0,1] row_mask:0xf bank_mask:0xf
  s_nop 1
  v_add_f32_dpp v7, v7, v7 row_half_mirror row_mask:0xf bank_mask:0xf
  v_cndmask_b32 v28, v28, v7, vcc
  s_lshl_b64 vcc, vcc, 1
L_kb_join:
  s_add_u32 s14, s14, 1
  s_cmp_lt_u32 s14, 6
  s_cbranch_scc1 L_kloop
  s_mov_b32 s10, 0x3d93cd3a
  s_waitcnt vmcnt(4)
  buffer_load_dwordx4 v[100:103], v1, s[40:43], s77 offen offset:0 nt
  v_cvt_pk_bf16_f32 v160, v35, v35
  v_and_b32 v160, 0xffff0000, v160
  v_mul_f32 v160, s10, v160
  v_cvt_pk_bf16_f32 v160, v160, v160
  v_and_b32 v160, 0xffff0000, v160
  v_cvt_pk_bf16_f32 v161, v34, v34
  v_and_b32 v161, 0xffff0000, v161
  v_mul_f32 v161, s10, v161
  v_cvt_pk_bf16_f32 v161, v161, v161
  v_and_b32 v161, 0xffff0000, v161
  v_cvt_pk_bf16_f32 v162, v33, v33
  v_and_b32 v162, 0xffff0000, v162
  v_mul_f32 v162, s10, v162
  v_cvt_pk_bf16_f32 v162, v162, v162
  v_and_b32 v162, 0xffff0000, v162
  v_cvt_pk_bf16_f32 v163, v32, v32
  v_and_b32 v163, 0xffff0000, v163
  v_mul_f32 v163, s10, v163
  v_cvt_pk_bf16_f32 v163, v163, v163
  v_and_b32 v163, 0xffff0000, v163
  v_cvt_pk_bf16_f32 v164, v31, v31
  v_and_b32 v164, 0xffff0000, v164
  v_mul_f32 v164, s10, v164
  v_cvt_pk_bf16_f32 v164, v164, v164
  v_and_b32 v164, 0xffff0000, v164
  v_cvt_pk_bf16_f32 v165, v30, v30
  v_and_b32 v165, 0xffff0000, v165
  v_mul_f32 v165, s10, v165
  v_cvt_pk_bf16_f32 v165, v165, v165
  v_and_b32 v165, 0xffff0000, v165
  v_cvt_pk_bf16_f32 v166, v29, v29
  v_and_b32 v166, 0xffff0000, v166
  v_mul_f32 v166, s10, v166
  v_cvt_pk_bf16_f32 v166, v166, v166
  v_and_b32 v166, 0xffff0000, v166
  v_cvt_pk_bf16_f32 v167, v28, v28
  v_and_b32 v167, 0xffff0000, v167
  v_mul_f32 v167, s10, v167
  v_cvt_pk_bf16_f32 v167, v167, v167
  v_and_b32 v167, 0xffff0000, v167
  v_mov_b32 v168, v160
  v_mov_b32 v169, v161
  v_mov_b32 v170, v162
  v_mov_b32 v171, v163
  v_mov_b32 v172, v164
  v_mov_b32 v173, v165
  v_mov_b32 v174, v166
  v_mov_b32 v175, v167
  s_nop 1
  v_permlane32_swap_b32 v168, v170
  v_permlane32_swap_b32 v169, v171
  v_permlane32_swap_b32 v172, v174
  v_permlane32_swap_b32 v173, v175
  v_max_f32 v168, v168, v170
  v_max_f32 v169, v169, v171
  v_max_f32 v172, v172, v174
  v_max_f32 v173, v173, v175
  s_nop 0
  v_permlane16_swap_b32 v168, v169
  v_permlane16_swap_b32 v172, v173
  s_nop 0
  v_max_f32 v176, v168, v169
  v_max_f32 v178, v172, v173
  s_nop 0
  v_max_f32_dpp v176, v176, v176 quad_perm:[1,0,3,2] row_mask:0xf bank_mask:0xf
  v_max_f32_dpp v178, v178, v178 quad_perm:[1,0,3,2] row_mask:0xf bank_mask:0xf
  s_nop 0
  v_max_f32_dpp v176, v176, v176 quad_perm:[2,3,0,1] row_mask:0xf bank_mask:0xf
  v_max_f32_dpp v178, v178, v178 quad_perm:[2,3,0,1] row_mask:0xf bank_mask:0xf
  s_nop 0
  v_max_f32_dpp v176, v176, v176 row_half_mirror row_mask:0xf bank_mask:0xf
  v_max_f32_dpp v178, v178, v178 row_half_mirror row_mask:0xf bank_mask:0xf
  s_nop 0
  v_max_f32_dpp v176, v176, v176 row_mirror row_mask:0xf bank_mask:0xf
  v_max_f32_dpp v178, v178, v178 row_mirror row_mask:0xf bank_mask:0xf
  s_nop 0
  v_readlane_b32 s70, v176, 0
  v_readlane_b32 s71, v176, 16
  v_readlane_b32 s72, v176, 32
  v_readlane_b32 s73, v176, 48
  v_readlane_b32 s82, v178, 0
  v_readlane_b32 s83, v178, 16
  v_readlane_b32 s84, v178, 32
  v_readlane_b32 s85, v178, 48
  s_waitcnt vmcnt(4)
  buffer_load_dwordx4 v[104:107], v1, s[40:43], s77 offen offset:128 nt
  v_subrev_f32 v160, s70, v160
  v_mul_f32 v160, s68, v160
  v_exp_f32 v160, v160
  v_subrev_f32 v161, s71, v161
  v_mul_f32 v161, s68, v161
  v_exp_f32 v161, v161
  v_subrev_f32 v162, s72, v162
  v_mul_f32 v162, s68, v162
  v_exp_f32 v162, v162
  v_subrev_f32 v163, s73, v163
  v_mul_f32 v163, s68, v163
  v_exp_f32 v163, v163
  v_subrev_f32 v164, s82, v164
  v_mul_f32 v164, s68, v164
  v_exp_f32 v164, v164
  v_subrev_f32 v165, s83, v165
  v_mul_f32 v165, s68, v165
  v_exp_f32 v165, v165
  v_subrev_f32 v166, s84, v166
  v_mul_f32 v166, s68, v166
  v_exp_f32 v166, v166
  v_subrev_f32 v167, s85, v167
  v_mul_f32 v167, s68, v167
  v_exp_f32 v167, v167
  s_nop 0
  v_cvt_pk_bf16_f32 v35, v160, v160
  v_cvt_pk_bf16_f32 v34, v161, v161
  v_cvt_pk_bf16_f32 v33, v162, v162
  v_cvt_pk_bf16_f32 v32, v163, v163
  v_cvt_pk_bf16_f32 v31, v164, v164
  v_cvt_pk_bf16_f32 v30, v165, v165
  v_cvt_pk_bf16_f32 v29, v166, v166
  v_cvt_pk_bf16_f32 v28, v167, v167
  s_nop 1
  v_permlane32_swap_b32 v160, v162
  v_permlane32_swap_b32 v161, v163
  v_permlane32_swap_b32 v164, v166
  v_permlane32_swap_b32 v165, v167
  v_add_f32 v160, v160, v162
  v_add_f32 v161, v161, v163
  v_add_f32 v164, v164, v166
  v_add_f32 v165, v165, v167
  s_nop 0
  v_permlane16_swap_b32 v160, v161
  v_permlane16_swap_b32 v164, v165
  s_nop 0
  v_add_f32 v177, v160, v161
  v_add_f32 v179, v164, v165
  s_nop 0
  v_add_f32_dpp v177, v177, v177 quad_perm:[1,0,3,2] row_mask:0xf bank_mask:0xf
  v_add_f32_dpp v179, v179, v179 quad_perm:[1,0,3,2] row_mask:0xf bank_mask:0xf
  s_nop 0
  v_add_f32_dpp v177, v177, v177 quad_perm:[2,3,0,1] row_mask:0xf bank_mask:0xf
  v_add_f32_dpp v179, v179, v179 quad_perm:[2,3,0,1] row_mask:0xf bank_mask:0xf
  s_nop 0
  v_add_f32_dpp v177, v177, v177 row_half_mirror row_mask:0xf bank_mask:0xf
  v_add_f32_dpp v179, v179, v179 row_half_mirror row_mask:0xf bank_mask:0xf
  s_nop 0
  v_add_f32_dpp v177, v177, v177 row_mirror row_mask:0xf bank_mask:0xf
  v_add_f32_dpp v179, v179, v179 row_mirror row_mask:0xf bank_mask:0xf
  s_nop 0
  v_min_u32 v176, -2, v176
  v_min_u32 v177, -2, v177
  v_min_u32 v178, -2, v178
  v_min_u32 v179, -2, v179
  s_waitcnt vmcnt(4)
  buffer_load_dwordx4 v[108:111], v1, s[40:43], s77 offen offset:256 nt
  s_mov_b32 exec_lo, 0x10001
  s_mov_b32 exec_hi, 0x10001
  ds_write_b64 v41, v[176:177] offset:3584
  ds_write_b64 v41, v[178:179] offset:3712
  s_mov_b64 exec, -1
  s_memrealtime s[88:89]
  ds_read_b32 v42, v43 offset:3840
  s_add_u32 s90, s90, 40
  s_cmp_lt_u32 s6, 5
  s_movk_i32 s10, 18
  s_cselect_b32 s10, -11, s10
  s_add_u32 s90, s90, s10
  s_mov_b32 s14, 0
L_vloop:
  s_waitcnt lgkmcnt(0)
  s_mov_b32 exec_lo, 0xff00ff
  s_mov_b32 exec_hi, 0xff00ff00
  ds_write_b128 v40, v[16:19] offset:4096
  ds_write_b128 v40, v[20:23] offset:4352
  ds_write_b128 v40, v[24:27] offset:4608
  s_mov_b64 exec, -1
  v_readfirstlane_b32 s12, v42
  s_sub_u32 s11, s88, s90
  s_add_u32 s90, s90, 326
  s_add_u32 s92, s92, 1
  v_mov_b32 v44, s11
  v_mov_b32 v45, s92
  v_mov_b32 v46, s88
  ds_write_b96 v48, v[44:46] offset:3904
  s_cmp_eq_u32 s12, 0
  s_cselect_b32 s91, s91, s12
  s_sub_u32 s11, s11, s91
  s_cmp_lt_i32 s11, -30
  s_cbranch_scc1 L_va_l0
  s_cmp_lt_i32 s11, 40
  s_cbranch_scc1 L_va_l1
  s_cmp_lt_i32 s11, 140
  s_cbranch_scc1 L_va_l2
L_va_l3:
  v_mov_b32_dpp v6, v35 quad_perm:[0,0,0,0] row_mask:0xf bank_mask:0xf
  v_and_b32_dpp v36, v35, v2 quad_perm:[0,0,0,0] row_mask:0xf bank_mask:0xf
  v_and_b32_dpp v37, v35, v3 quad_perm:[0,0,0,0] row_mask:0xf bank_mask:0xf
  v_and_b32_dpp v38, v6, v4 row_half_mirror row_mask:0xf bank_mask:0xf
  v_and_b32_dpp v39, v6, v5 row_half_mirror row_mask:0xf bank_mask:0xf
  s_waitcnt vmcnt(7)
  buffer_load_dwordx4 v[112:115], v1, s[40:43], s78 offen offset:0 nt
  v_mfma_f32_16x16x32_bf16 v[16:19], v[36:39], v[64:67], 0
  s_waitcnt vmcnt(7)
  buffer_load_dwordx4 v[116:119], v1, s[40:43], s78 offen offset:128 nt
  v_mfma_f32_16x16x32_bf16 v[20:23], v[36:39], v[68:71], 0
  s_waitcnt vmcnt(7)
  buffer_load_dwordx4 v[120:123], v1, s[40:43], s78 offen offset:256 nt
  v_mfma_f32_16x16x32_bf16 v[24:27], v[36:39], v[72:75], 0
  v_mov_b32_dpp v6, v35 quad_perm:[1,1,1,1] row_mask:0xf bank_mask:0xf
  v_and_b32_dpp v36, v35, v2 quad_perm:[1,1,1,1] row_mask:0xf bank_mask:0xf
  v_and_b32_dpp v37, v35, v3 quad_perm:[1,1,1,1] row_mask:0xf bank_mask:0xf
  v_and_b32_dpp v38, v6, v4 row_half_mirror row_mask:0xf bank_mask:0xf
  v_and_b32_dpp v39, v6, v5 row_half_mirror row_mask:0xf bank_mask:0xf
  s_waitcnt vmcnt(7)
  buffer_load_dwordx4 v[124:127], v1, s[40:43], s79 offen offset:0 nt
  v_mfma_f32_16x16x32_bf16 v[16:19], v[36:39], v[76:79], v[16:19]
  s_waitcnt vmcnt(7)
  buffer_load_dwordx4 v[128:131], v1, s[40:43], s79 offen offset:128 nt
  v_mfma_f32_16x16x32_bf16 v[20:23], v[36:39], v[80:83], v[20:23]
  s_waitcnt vmcnt(7)
  buffer_load_dwordx4 v[132:135], v1, s[40:43], s79 offen offset:256 nt
  s_memrealtime s[88:89]
  v_mfma_f32_16x16x32_bf16 v[24:27], v[36:39], v[84:87], v[24:27]
  s_branch L_va_join
L_va_l2:
  v_mov_b32_dpp v6, v35 quad_perm:[0,0,0,0] row_mask:0xf bank_mask:0xf
  v_and_b32_dpp v36, v35, v2 quad_perm:[0,0,0,0] row_mask:0xf bank_mask:0xf
  v_and_b32_dpp v37, v35, v3 quad_perm:[0,0,0,0] row_mask:0xf bank_mask:0xf
  v_and_b32_dpp v38, v6, v4 row_half_mirror row_mask:0xf bank_mask:0xf
  v_and_b32_dpp v39, v6, v5 row_half_mirror row_mask:0xf bank_mask:0xf
  s_waitcnt vmcnt(5)
  buffer_load_dwordx4 v[112:115], v1, s[40:43], s78 offen offset:0 nt
  v_mfma_f32_16x16x32_bf16 v[16:19], v[36:39], v[64:67], 0
  s_waitcnt vmcnt(5)
  buffer_load_dwordx4 v[116:119], v1, s[40:43], s78 offen offset:128 nt
  v_mfma_f32_16x16x32_bf16 v[20:23], v[36:39], v[68:71], 0
  s_waitcnt vmcnt(5)
  buffer_load_dwordx4 v[120:123], v1, s[40:43], s78 offen offset:256 nt
  v_mfma_f32_16x16x32_bf16 v[24:27], v[36:39], v[72:75], 0
  v_mov_b32_dpp v6, v35 quad_perm:[1,1,1,1] row_mask:0xf bank_mask:0xf
  v_and_b32_dpp v36, v35, v2 quad_perm:[1,1,1,1] row_mask:0xf bank_mask:0xf
  v_and_b32_dpp v37, v35, v3 quad_perm:[1,1,1,1] row_mask:0xf bank_mask:0xf
  v_and_b32_dpp v38, v6, v4 row_half_mirror row_mask:0xf bank_mask:0xf
  v_and_b32_dpp v39, v6, v5 row_half_mirror row_mask:0xf bank_mask:0xf
  s_waitcnt vmcnt(5)
  buffer_load_dwordx4 v[124:127], v1, s[40:43], s79 offen offset:0 nt
  v_mfma_f32_16x16x32_bf16 v[16:19], v[36:39], v[76:79], v[16:19]
  s_waitcnt vmcnt(5)
  buffer_load_dwordx4 v[128:131], v1, s[40:43], s79 offen offset:128 nt
  v_mfma_f32_16x16x32_bf16 v[20:23], v[36:39], v[80:83], v[20:23]
  s_waitcnt vmcnt(5)
  buffer_load_dwordx4 v[132:135], v1, s[40:43], s79 offen offset:256 nt
  s_memrealtime s[88:89]
  v_mfma_f32_16x16x32_bf16 v[24:27], v[36:39], v[84:87], v[24:27]
  s_branch L_va_join
L_va_l1:
  v_mov_b32_dpp v6, v35 quad_perm:[0,0,0,0] row_mask:0xf bank_mask:0xf
  v_and_b32_dpp v36, v35, v2 quad_perm:[0,0,0,0] row_mask:0xf bank_mask:0xf
  v_and_b32_dpp v37, v35, v3 quad_perm:[0,0,0,0] row_mask:0xf bank_mask:0xf
  v_and_b32_dpp v38, v6, v4 row_half_mirror row_mask:0xf bank_mask:0xf
  v_and_b32_dpp v39, v6, v5 row_half_mirror row_mask:0xf bank_mask:0xf
  s_waitcnt vmcnt(4)
  buffer_load_dwordx4 v[112:115], v1, s[40:43], s78 offen offset:0 nt
  v_mfma_f32_16x16x32_bf16 v[16:19], v[36:39], v[64:67], 0
  s_waitcnt vmcnt(4)
  buffer_load_dwordx4 v[116:119], v1, s[40:43], s78 offen offset:128 nt
  v_mfma_f32_16x16x32_bf16 v[20:23], v[36:39], v[68:71], 0
  s_waitcnt vmcnt(4)
  buffer_load_dwordx4 v[120:123], v1, s[40:43], s78 offen offset:256 nt
  v_mfma_f32_16x16x32_bf16 v[24:27], v[36:39], v[72:75], 0
  v_mov_b32_dpp v6, v35 quad_perm:[1,1,1,1] row_mask:0xf bank_mask:0xf
  v_and_b32_dpp v36, v35, v2 quad_perm:[1,1,1,1] row_mask:0xf bank_mask:0xf
  v_and_b32_dpp v37, v35, v3 quad_perm:[1,1,1,1] row_mask:0xf bank_mask:0xf
  v_and_b32_dpp v38, v6, v4 row_half_mirror row_mask:0xf bank_mask:0xf
  v_and_b32_dpp v39, v6, v5 row_half_mirror row_mask:0xf bank_mask:0xf
  s_waitcnt vmcnt(4)
  buffer_load_dwordx4 v[124:127], v1, s[40:43], s79 offen offset:0 nt
  v_mfma_f32_16x16x32_bf16 v[16:19], v[36:39], v[76:79], v[16:19]
  s_waitcnt vmcnt(4)
  buffer_load_dwordx4 v[128:131], v1, s[40:43], s79 offen offset:128 nt
  v_mfma_f32_16x16x32_bf16 v[20:23], v[36:39], v[80:83], v[20:23]
  s_waitcnt vmcnt(4)
  buffer_load_dwordx4 v[132:135], v1, s[40:43], s79 offen offset:256 nt
  s_memrealtime s[88:89]
  v_mfma_f32_16x16x32_bf16 v[24:27], v[36:39], v[84:87], v[24:27]
  s_branch L_va_join
L_va_l0:
  v_mov_b32_dpp v6, v35 quad_perm:[0,0,0,0] row_mask:0xf bank_mask:0xf
  v_and_b32_dpp v36, v35, v2 quad_perm:[0,0,0,0] row_mask:0xf bank_mask:0xf
  v_and_b32_dpp v37, v35, v3 quad_perm:[0,0,0,0] row_mask:0xf bank_mask:0xf
  v_and_b32_dpp v38, v6, v4 row_half_mirror row_mask:0xf bank_mask:0xf
  v_and_b32_dpp v39, v6, v5 row_half_mirror row_mask:0xf bank_mask:0xf
  s_waitcnt vmcnt(3)
  buffer_load_dwordx4 v[112:115], v1, s[40:43], s78 offen offset:0 nt
  v_mfma_f32_16x16x32_bf16 v[16:19], v[36:39], v[64:67], 0
  s_waitcnt vmcnt(3)
  buffer_load_dwordx4 v[116:119], v1, s[40:43], s78 offen offset:128 nt
  v_mfma_f32_16x16x32_bf16 v[20:23], v[36:39], v[68:71], 0
  s_waitcnt vmcnt(3)
  buffer_load_dwordx4 v[120:123], v1, s[40:43], s78 offen offset:256 nt
  v_mfma_f32_16x16x32_bf16 v[24:27], v[36:39], v[72:75], 0
  v_mov_b32_dpp v6, v35 quad_perm:[1,1,1,1] row_mask:0xf bank_mask:0xf
  v_and_b32_dpp v36, v35, v2 quad_perm:[1,1,1,1] row_mask:0xf bank_mask:0xf
  v_and_b32_dpp v37, v35, v3 quad_perm:[1,1,1,1] row_mask:0xf bank_mask:0xf
  v_and_b32_dpp v38, v6, v4 row_half_mirror row_mask:0xf bank_mask:0xf
  v_and_b32_dpp v39, v6, v5 row_half_mirror row_mask:0xf bank_mask:0xf
  s_waitcnt vmcnt(3)
  buffer_load_dwordx4 v[124:127], v1, s[40:43], s79 offen offset:0 nt
  v_mfma_f32_16x16x32_bf16 v[16:19], v[36:39], v[76:79], v[16:19]
  s_waitcnt vmcnt(3)
  buffer_load_dwordx4 v[128:131], v1, s[40:43], s79 offen offset:128 nt
  v_mfma_f32_16x16x32_bf16 v[20:23], v[36:39], v[80:83], v[20:23]
  s_waitcnt vmcnt(3)
  buffer_load_dwordx4 v[132:135], v1, s[40:43], s79 offen offset:256 nt
  s_memrealtime s[88:89]
  v_mfma_f32_16x16x32_bf16 v[24:27], v[36:39], v[84:87], v[24:27]
L_va_join:
  s_waitcnt lgkmcnt(0)
  s_sub_u32 s11, s88, s90
  s_sub_u32 s11, s11, s91
  s_add_u32 s11, s11, 244
  s_cmp_lt_i32 s11, -30
  s_cbranch_scc1 L_vb_l0
  s_cmp_lt_i32 s11, 40
  s_cbranch_scc1 L_vb_l1
  s_cmp_lt_i32 s11, 140
  s_cbranch_scc1 L_vb_l2
L_vb_l3:
  v_mov_b32_dpp v6, v35 quad_perm:[2,2,2,2] row_mask:0xf bank_mask:0xf
  v_and_b32_dpp v36, v35, v2 quad_perm:[2,2,2,2] row_mask:0xf bank_mask:0xf
  v_and_b32_dpp v37, v35, v3 quad_perm:[2,2,2,2] row_mask:0xf bank_mask:0xf
  v_and_b32_dpp v38, v6, v4 row_half_mirror row_mask:0xf bank_mask:0xf
  v_and_b32_dpp v39, v6, v5 row_half_mirror row_mask:0xf bank_mask:0xf
  s_waitcnt vmcnt(7)
  buffer_load_dwordx4 v[136:139], v1, s[40:43], s80 offen offset:0 nt
  v_mfma_f32_16x16x32_bf16 v[16:19], v[36:39], v[88:91], v[16:19]
  s_waitcnt vmcnt(7)
  buffer_load_dwordx4 v[140:143], v1, s[40:43], s80 offen offset:128 nt
  v_mfma_f32_16x16x32_bf16 v[20:23], v[36:39], v[92:95], v[20:23]
  s_waitcnt vmcnt(7)
  buffer_load_dwordx4 v[144:147], v1, s[40:43], s80 offen offset:256 nt
  v_mfma_f32_16x16x32_bf16 v[24:27], v[36:39], v[96:99], v[24:27]
  v_mov_b32_dpp v6, v35 quad_perm:[3,3,3,3] row_mask:0xf bank_mask:0xf
  v_and_b32_dpp v36, v35, v2 quad_perm:[3,3,3,3] row_mask:0xf bank_mask:0xf
  v_and_b32_dpp v37, v35, v3 quad_perm:[3,3,3,3] row_mask:0xf bank_mask:0xf
  v_and_b32_dpp v38, v6, v4 row_half_mirror row_mask:0xf bank_mask:0xf
  v_and_b32_dpp v39, v6, v5 row_half_mirror row_mask:0xf bank_mask:0xf
  s_waitcnt vmcnt(7)
  buffer_load_dwordx4 v[148:151], v1, s[40:43], s81 offen offset:0 nt
  v_mfma_f32_16x16x32_bf16 v[16:19], v[36:39], v[100:103], v[16:19]
  s_waitcnt vmcnt(7)
  buffer_load_dwordx4 v[152:155], v1, s[40:43], s81 offen offset:128 nt
  v_mfma_f32_16x16x32_bf16 v[20:23], v[36:39], v[104:107], v[20:23]
  s_waitcnt vmcnt(7)
  buffer_load_dwordx4 v[156:159], v1, s[40:43], s81 offen offset:256 nt
  s_memrealtime s[88:89]
  v_mfma_f32_16x16x32_bf16 v[24:27], v[36:39], v[108:111], v[24:27]
  s_branch L_vb_join
L_vb_l2:
  v_mov_b32_dpp v6, v35 quad_perm:[2,2,2,2] row_mask:0xf bank_mask:0xf
  v_and_b32_dpp v36, v35, v2 quad_perm:[2,2,2,2] row_mask:0xf bank_mask:0xf
  v_and_b32_dpp v37, v35, v3 quad_perm:[2,2,2,2] row_mask:0xf bank_mask:0xf
  v_and_b32_dpp v38, v6, v4 row_half_mirror row_mask:0xf bank_mask:0xf
  v_and_b32_dpp v39, v6, v5 row_half_mirror row_mask:0xf bank_mask:0xf
  s_waitcnt vmcnt(5)
  buffer_load_dwordx4 v[136:139], v1, s[40:43], s80 offen offset:0 nt
  v_mfma_f32_16x16x32_bf16 v[16:19], v[36:39], v[88:91], v[16:19]
  s_waitcnt vmcnt(5)
  buffer_load_dwordx4 v[140:143], v1, s[40:43], s80 offen offset:128 nt
  v_mfma_f32_16x16x32_bf16 v[20:23], v[36:39], v[92:95], v[20:23]
  s_waitcnt vmcnt(5)
  buffer_load_dwordx4 v[144:147], v1, s[40:43], s80 offen offset:256 nt
  v_mfma_f32_16x16x32_bf16 v[24:27], v[36:39], v[96:99], v[24:27]
  v_mov_b32_dpp v6, v35 quad_perm:[3,3,3,3] row_mask:0xf bank_mask:0xf
  v_and_b32_dpp v36, v35, v2 quad_perm:[3,3,3,3] row_mask:0xf bank_mask:0xf
  v_and_b32_dpp v37, v35, v3 quad_perm:[3,3,3,3] row_mask:0xf bank_mask:0xf
  v_and_b32_dpp v38, v6, v4 row_half_mirror row_mask:0xf bank_mask:0xf
  v_and_b32_dpp v39, v6, v5 row_half_mirror row_mask:0xf bank_mask:0xf
  s_waitcnt vmcnt(5)
  buffer_load_dwordx4 v[148:151], v1, s[40:43], s81 offen offset:0 nt
  v_mfma_f32_16x16x32_bf16 v[16:19], v[36:39], v[100:103], v[16:19]
  s_waitcnt vmcnt(5)
  buffer_load_dwordx4 v[152:155], v1, s[40:43], s81 offen offset:128 nt
  v_mfma_f32_16x16x32_bf16 v[20:23], v[36:39], v[104:107], v[20:23]
  s_waitcnt vmcnt(5)
  buffer_load_dwordx4 v[156:159], v1, s[40:43], s81 offen offset:256 nt
  s_memrealtime s[88:89]
  v_mfma_f32_16x16x32_bf16 v[24:27], v[36:39], v[108:111], v[24:27]
  s_branch L_vb_join
L_vb_l1:
  v_mov_b32_dpp v6, v35 quad_perm:[2,2,2,2] row_mask:0xf bank_mask:0xf
  v_and_b32_dpp v36, v35, v2 quad_perm:[2,2,2,2] row_mask:0xf bank_mask:0xf
  v_and_b32_dpp v37, v35, v3 quad_perm:[2,2,2,2] row_mask:0xf bank_mask:0xf
  v_and_b32_dpp v38, v6, v4 row_half_mirror row_mask:0xf bank_mask:0xf
  v_and_b32_dpp v39, v6, v5 row_half_mirror row_mask:0xf bank_mask:0xf
  s_waitcnt vmcnt(4)
  buffer_load_dwordx4 v[136:139], v1, s[40:43], s80 offen offset:0 nt
  v_mfma_f32_16x16x32_bf16 v[16:19], v[36:39], v[88:91], v[16:19]
  s_waitcnt vmcnt(4)
  buffer_load_dwordx4 v[140:143], v1, s[40:43], s80 offen offset:128 nt
  v_mfma_f32_16x16x32_bf16 v[20:23], v[36:39], v[92:95], v[20:23]
  s_waitcnt vmcnt(4)
  buffer_load_dwordx4 v[144:147], v1, s[40:43], s80 offen offset:256 nt
  v_mfma_f32_16x16x32_bf16 v[24:27], v[36:39], v[96:99], v[24:27]
  v_mov_b32_dpp v6, v35 quad_perm:[3,3,3,3] row_mask:0xf bank_mask:0xf
  v_and_b32_dpp v36, v35, v2 quad_perm:[3,3,3,3] row_mask:0xf bank_mask:0xf
  v_and_b32_dpp v37, v35, v3 quad_perm:[3,3,3,3] row_mask:0xf bank_mask:0xf
  v_and_b32_dpp v38, v6, v4 row_half_mirror row_mask:0xf bank_mask:0xf
  v_and_b32_dpp v39, v6, v5 row_half_mirror row_mask:0xf bank_mask:0xf
  s_waitcnt vmcnt(4)
  buffer_load_dwordx4 v[148:151], v1, s[40:43], s81 offen offset:0 nt
  v_mfma_f32_16x16x32_bf16 v[16:19], v[36:39], v[100:103], v[16:19]
  s_waitcnt vmcnt(4)
  buffer_load_dwordx4 v[152:155], v1, s[40:43], s81 offen offset:128 nt
  v_mfma_f32_16x16x32_bf16 v[20:23], v[36:39], v[104:107], v[20:23]
  s_waitcnt vmcnt(4)
  buffer_load_dwordx4 v[156:159], v1, s[40:43], s81 offen offset:256 nt
  s_memrealtime s[88:89]
  v_mfma_f32_16x16x32_bf16 v[24:27], v[36:39], v[108:111], v[24:27]
  s_branch L_vb_join
L_vb_l0:
  v_mov_b32_dpp v6, v35 quad_perm:[2,2,2,2] row_mask:0xf bank_mask:0xf
  v_and_b32_dpp v36, v35, v2 quad_perm:[2,2,2,2] row_mask:0xf bank_mask:0xf
  v_and_b32_dpp v37, v35, v3 quad_perm:[2,2,2,2] row_mask:0xf bank_mask:0xf
  v_and_b32_dpp v38, v6, v4 row_half_mirror row_mask:0xf bank_mask:0xf
  v_and_b32_dpp v39, v6, v5 row_half_mirror row_mask:0xf bank_mask:0xf
  s_waitcnt vmcnt(3)
  buffer_load_dwordx4 v[136:139], v1, s[40:43], s80 offen offset:0 nt
  v_mfma_f32_16x16x32_bf16 v[16:19], v[36:39], v[88:91], v[16:19]
  s_waitcnt vmcnt(3)
  buffer_load_dwordx4 v[140:143], v1, s[40:43], s80 offen offset:128 nt
  v_mfma_f32_16x16x32_bf16 v[20:23], v[36:39], v[92:95], v[20:23]
  s_waitcnt vmcnt(3)
  buffer_load_dwordx4 v[144:147], v1, s[40:43], s80 offen offset:256 nt
  v_mfma_f32_16x16x32_bf16 v[24:27], v[36:39], v[96:99], v[24:27]
  v_mov_b32_dpp v6, v35 quad_perm:[3,3,3,3] row_mask:0xf bank_mask:0xf
  v_and_b32_dpp v36, v35, v2 quad_perm:[3,3,3,3] row_mask:0xf bank_mask:0xf
  v_and_b32_dpp v37, v35, v3 quad_perm:[3,3,3,3] row_mask:0xf bank_mask:0xf
  v_and_b32_dpp v38, v6, v4 row_half_mirror row_mask:0xf bank_mask:0xf
  v_and_b32_dpp v39, v6, v5 row_half_mirror row_mask:0xf bank_mask:0xf
  s_waitcnt vmcnt(3)
  buffer_load_dwordx4 v[148:151], v1, s[40:43], s81 offen offset:0 nt
  v_mfma_f32_16x16x32_bf16 v[16:19], v[36:39], v[100:103], v[16:19]
  s_waitcnt vmcnt(3)
  buffer_load_dwordx4 v[152:155], v1, s[40:43], s81 offen offset:128 nt
  v_mfma_f32_16x16x32_bf16 v[20:23], v[36:39], v[104:107], v[20:23]
  s_waitcnt vmcnt(3)
  buffer_load_dwordx4 v[156:159], v1, s[40:43], s81 offen offset:256 nt
  s_memrealtime s[88:89]
  v_mfma_f32_16x16x32_bf16 v[24:27], v[36:39], v[108:111], v[24:27]
L_vb_join:
  s_waitcnt lgkmcnt(0)
  s_sub_u32 s11, s88, s90
  s_sub_u32 s11, s11, s91
  s_add_u32 s11, s11, 163
  s_cmp_lt_i32 s11, -30
  s_cbranch_scc1 L_vc_l0
  s_cmp_lt_i32 s11, 40
  s_cbranch_scc1 L_vc_l1
  s_cmp_lt_i32 s11, 140
  s_cbranch_scc1 L_vc_l2
L_vc_l3:
  v_mov_b32_dpp v6, v35 quad_perm:[0,0,0,0] row_mask:0xf bank_mask:0xf
  v_and_b32_dpp v38, v35, v4 quad_perm:[0,0,0,0] row_mask:0xf bank_mask:0xf
  v_and_b32_dpp v39, v35, v5 quad_perm:[0,0,0,0] row_mask:0xf bank_mask:0xf
  v_and_b32_dpp v36, v6, v2 row_half_mirror row_mask:0xf bank_mask:0xf
  v_and_b32_dpp v37, v6, v3 row_half_mirror row_mask:0xf bank_mask:0xf
  s_add_u32 s40, s40, 25165824
  s_addc_u32 s41, s41, 0
  s_waitcnt vmcnt(7)
  buffer_load_dwordx4 v[64:67], v1, s[40:43], s74 offen offset:0 nt
  v_mfma_f32_16x16x32_bf16 v[16:19], v[36:39], v[112:115], v[16:19]
  s_waitcnt vmcnt(7)
  buffer_load_dwordx4 v[68:71], v1, s[40:43], s74 offen offset:128 nt
  v_mfma_f32_16x16x32_bf16 v[20:23], v[36:39], v[116:119], v[20:23]
  s_waitcnt vmcnt(7)
  buffer_load_dwordx4 v[72:75], v1, s[40:43], s74 offen offset:256 nt
  v_mfma_f32_16x16x32_bf16 v[24:27], v[36:39], v[120:123], v[24:27]
  v_mov_b32_dpp v6, v35 quad_perm:[1,1,1,1] row_mask:0xf bank_mask:0xf
  v_and_b32_dpp v38, v35, v4 quad_perm:[1,1,1,1] row_mask:0xf bank_mask:0xf
  v_and_b32_dpp v39, v35, v5 quad_perm:[1,1,1,1] row_mask:0xf bank_mask:0xf
  v_and_b32_dpp v36, v6, v2 row_half_mirror row_mask:0xf bank_mask:0xf
  v_and_b32_dpp v37, v6, v3 row_half_mirror row_mask:0xf bank_mask:0xf
  s_waitcnt vmcnt(7)
  buffer_load_dwordx4 v[76:79], v1, s[40:43], s75 offen offset:0 nt
  v_mfma_f32_16x16x32_bf16 v[16:19], v[36:39], v[124:127], v[16:19]
  s_waitcnt vmcnt(7)
  buffer_load_dwordx4 v[80:83], v1, s[40:43], s75 offen offset:128 nt
  v_mfma_f32_16x16x32_bf16 v[20:23], v[36:39], v[128:131], v[20:23]
  s_waitcnt vmcnt(7)
  buffer_load_dwordx4 v[84:87], v1, s[40:43], s75 offen offset:256 nt
  s_memrealtime s[88:89]
  v_mfma_f32_16x16x32_bf16 v[24:27], v[36:39], v[132:135], v[24:27]
  s_branch L_vc_join
L_vc_l2:
  v_mov_b32_dpp v6, v35 quad_perm:[0,0,0,0] row_mask:0xf bank_mask:0xf
  v_and_b32_dpp v38, v35, v4 quad_perm:[0,0,0,0] row_mask:0xf bank_mask:0xf
  v_and_b32_dpp v39, v35, v5 quad_perm:[0,0,0,0] row_mask:0xf bank_mask:0xf
  v_and_b32_dpp v36, v6, v2 row_half_mirror row_mask:0xf bank_mask:0xf
  v_and_b32_dpp v37, v6, v3 row_half_mirror row_mask:0xf bank_mask:0xf
  s_add_u32 s40, s40, 25165824
  s_addc_u32 s41, s41, 0
  s_waitcnt vmcnt(5)
  buffer_load_dwordx4 v[64:67], v1, s[40:43], s74 offen offset:0 nt
  v_mfma_f32_16x16x32_bf16 v[16:19], v[36:39], v[112:115], v[16:19]
  s_waitcnt vmcnt(5)
  buffer_load_dwordx4 v[68:71], v1, s[40:43], s74 offen offset:128 nt
  v_mfma_f32_16x16x32_bf16 v[20:23], v[36:39], v[116:119], v[20:23]
  s_waitcnt vmcnt(5)
  buffer_load_dwordx4 v[72:75], v1, s[40:43], s74 offen offset:256 nt
  v_mfma_f32_16x16x32_bf16 v[24:27], v[36:39], v[120:123], v[24:27]
  v_mov_b32_dpp v6, v35 quad_perm:[1,1,1,1] row_mask:0xf bank_mask:0xf
  v_and_b32_dpp v38, v35, v4 quad_perm:[1,1,1,1] row_mask:0xf bank_mask:0xf
  v_and_b32_dpp v39, v35, v5 quad_perm:[1,1,1,1] row_mask:0xf bank_mask:0xf
  v_and_b32_dpp v36, v6, v2 row_half_mirror row_mask:0xf bank_mask:0xf
  v_and_b32_dpp v37, v6, v3 row_half_mirror row_mask:0xf bank_mask:0xf
  s_waitcnt vmcnt(5)
  buffer_load_dwordx4 v[76:79], v1, s[40:43], s75 offen offset:0 nt
  v_mfma_f32_16x16x32_bf16 v[16:19], v[36:39], v[124:127], v[16:19]
  s_waitcnt vmcnt(5)
  buffer_load_dwordx4 v[80:83], v1, s[40:43], s75 offen offset:128 nt
  v_mfma_f32_16x16x32_bf16 v[20:23], v[36:39], v[128:131], v[20:23]
  s_waitcnt vmcnt(5)
  buffer_load_dwordx4 v[84:87], v1, s[40:43], s75 offen offset:256 nt
  s_memrealtime s[88:89]
  v_mfma_f32_16x16x32_bf16 v[24:27], v[36:39], v[132:135], v[24:27]
  s_branch L_vc_join
L_vc_l1:
  v_mov_b32_dpp v6, v35 quad_perm:[0,0,0,0] row_mask:0xf bank_mask:0xf
  v_and_b32_dpp v38, v35, v4 quad_perm:[0,0,0,0] row_mask:0xf bank_mask:0xf
  v_and_b32_dpp v39, v35, v5 quad_perm:[0,0,0,0] row_mask:0xf bank_mask:0xf
  v_and_b32_dpp v36, v6, v2 row_half_mirror row_mask:0xf bank_mask:0xf
  v_and_b32_dpp v37, v6, v3 row_half_mirror row_mask:0xf bank_mask:0xf
  s_add_u32 s40, s40, 25165824
  s_addc_u32 s41, s41, 0
  s_waitcnt vmcnt(4)
  buffer_load_dwordx4 v[64:67], v1, s[40:43], s74 offen offset:0 nt
  v_mfma_f32_16x16x32_bf16 v[16:19], v[36:39], v[112:115], v[16:19]
  s_waitcnt vmcnt(4)
  buffer_load_dwordx4 v[68:71], v1, s[40:43], s74 offen offset:128 nt
  v_mfma_f32_16x16x32_bf16 v[20:23], v[36:39], v[116:119], v[20:23]
  s_waitcnt vmcnt(4)
  buffer_load_dwordx4 v[72:75], v1, s[40:43], s74 offen offset:256 nt
  v_mfma_f32_16x16x32_bf16 v[24:27], v[36:39], v[120:123], v[24:27]
  v_mov_b32_dpp v6, v35 quad_perm:[1,1,1,1] row_mask:0xf bank_mask:0xf
  v_and_b32_dpp v38, v35, v4 quad_perm:[1,1,1,1] row_mask:0xf bank_mask:0xf
  v_and_b32_dpp v39, v35, v5 quad_perm:[1,1,1,1] row_mask:0xf bank_mask:0xf
  v_and_b32_dpp v36, v6, v2 row_half_mirror row_mask:0xf bank_mask:0xf
  v_and_b32_dpp v37, v6, v3 row_half_mirror row_mask:0xf bank_mask:0xf
  s_waitcnt vmcnt(4)
  buffer_load_dwordx4 v[76:79], v1, s[40:43], s75 offen offset:0 nt
  v_mfma_f32_16x16x32_bf16 v[16:19], v[36:39], v[124:127], v[16:19]
  s_waitcnt vmcnt(4)
  buffer_load_dwordx4 v[80:83], v1, s[40:43], s75 offen offset:128 nt
  v_mfma_f32_16x16x32_bf16 v[20:23], v[36:39], v[128:131], v[20:23]
  s_waitcnt vmcnt(4)
  buffer_load_dwordx4 v[84:87], v1, s[40:43], s75 offen offset:256 nt
  s_memrealtime s[88:89]
  v_mfma_f32_16x16x32_bf16 v[24:27], v[36:39], v[132:135], v[24:27]
  s_branch L_vc_join
L_vc_l0:
  v_mov_b32_dpp v6, v35 quad_perm:[0,0,0,0] row_mask:0xf bank_mask:0xf
  v_and_b32_dpp v38, v35, v4 quad_perm:[0,0,0,0] row_mask:0xf bank_mask:0xf
  v_and_b32_dpp v39, v35, v5 quad_perm:[0,0,0,0] row_mask:0xf bank_mask:0xf
  v_and_b32_dpp v36, v6, v2 row_half_mirror row_mask:0xf bank_mask:0xf
  v_and_b32_dpp v37, v6, v3 row_half_mirror row_mask:0xf bank_mask:0xf
  s_add_u32 s40, s40, 25165824
  s_addc_u32 s41, s41, 0
  s_waitcnt vmcnt(3)
  buffer_load_dwordx4 v[64:67], v1, s[40:43], s74 offen offset:0 nt
  v_mfma_f32_16x16x32_bf16 v[16:19], v[36:39], v[112:115], v[16:19]
  s_waitcnt vmcnt(3)
  buffer_load_dwordx4 v[68:71], v1, s[40:43], s74 offen offset:128 nt
  v_mfma_f32_16x16x32_bf16 v[20:23], v[36:39], v[116:119], v[20:23]
  s_waitcnt vmcnt(3)
  buffer_load_dwordx4 v[72:75], v1, s[40:43], s74 offen offset:256 nt
  v_mfma_f32_16x16x32_bf16 v[24:27], v[36:39], v[120:123], v[24:27]
  v_mov_b32_dpp v6, v35 quad_perm:[1,1,1,1] row_mask:0xf bank_mask:0xf
  v_and_b32_dpp v38, v35, v4 quad_perm:[1,1,1,1] row_mask:0xf bank_mask:0xf
  v_and_b32_dpp v39, v35, v5 quad_perm:[1,1,1,1] row_mask:0xf bank_mask:0xf
  v_and_b32_dpp v36, v6, v2 row_half_mirror row_mask:0xf bank_mask:0xf
  v_and_b32_dpp v37, v6, v3 row_half_mirror row_mask:0xf bank_mask:0xf
  s_waitcnt vmcnt(3)
  buffer_load_dwordx4 v[76:79], v1, s[40:43], s75 offen offset:0 nt
  v_mfma_f32_16x16x32_bf16 v[16:19], v[36:39], v[124:127], v[16:19]
  s_waitcnt vmcnt(3)
  buffer_load_dwordx4 v[80:83], v1, s[40:43], s75 offen offset:128 nt
  v_mfma_f32_16x16x32_bf16 v[20:23], v[36:39], v[128:131], v[20:23]
  s_waitcnt vmcnt(3)
  buffer_load_dwordx4 v[84:87], v1, s[40:43], s75 offen offset:256 nt
  s_memrealtime s[88:89]
  v_mfma_f32_16x16x32_bf16 v[24:27], v[36:39], v[132:135], v[24:27]
L_vc_join:
  s_waitcnt lgkmcnt(0)
  s_sub_u32 s11, s88, s90
  s_sub_u32 s11, s11, s91
  s_add_u32 s11, s11, 81
  s_cmp_lt_i32 s11, -30
  s_cbranch_scc1 L_vd_l0
  s_cmp_lt_i32 s11, 40
  s_cbranch_scc1 L_vd_l1
  s_cmp_lt_i32 s11, 140
  s_cbranch_scc1 L_vd_l2
L_vd_l3:
  v_mov_b32_dpp v6, v35 quad_perm:[2,2,2,2] row_mask:0xf bank_mask:0xf
  v_and_b32_dpp v38, v35, v4 quad_perm:[2,2,2,2] row_mask:0xf bank_mask:0xf
  v_and_b32_dpp v39, v35, v5 quad_perm:[2,2,2,2] row_mask:0xf bank_mask:0xf
  v_and_b32_dpp v36, v6, v2 row_half_mirror row_mask:0xf bank_mask:0xf
  v_and_b32_dpp v37, v6, v3 row_half_mirror row_mask:0xf bank_mask:0xf
  s_waitcnt vmcnt(7)
  buffer_load_dwordx4 v[88:91], v1, s[40:43], s76 offen offset:0 nt
  v_mfma_f32_16x16x32_bf16 v[16:19], v[36:39], v[136:139], v[16:19]
  s_waitcnt vmcnt(7)
  buffer_load_dwordx4 v[92:95], v1, s[40:43], s76 offen offset:128 nt
  v_mfma_f32_16x16x32_bf16 v[20:23], v[36:39], v[140:143], v[20:23]
  s_waitcnt vmcnt(7)
  buffer_load_dwordx4 v[96:99], v1, s[40:43], s76 offen offset:256 nt
  v_mfma_f32_16x16x32_bf16 v[24:27], v[36:39], v[144:147], v[24:27]
  v_mov_b32_dpp v6, v35 quad_perm:[3,3,3,3] row_mask:0xf bank_mask:0xf
  v_and_b32_dpp v38, v35, v4 quad_perm:[3,3,3,3] row_mask:0xf bank_mask:0xf
  v_and_b32_dpp v39, v35, v5 quad_perm:[3,3,3,3] row_mask:0xf bank_mask:0xf
  v_and_b32_dpp v36, v6, v2 row_half_mirror row_mask:0xf bank_mask:0xf
  v_and_b32_dpp v37, v6, v3 row_half_mirror row_mask:0xf bank_mask:0xf
  s_waitcnt vmcnt(7)
  buffer_load_dwordx4 v[100:103], v1, s[40:43], s77 offen offset:0 nt
  v_mfma_f32_16x16x32_bf16 v[16:19], v[36:39], v[148:151], v[16:19]
  s_waitcnt vmcnt(7)
  buffer_load_dwordx4 v[104:107], v1, s[40:43], s77 offen offset:128 nt
  v_mfma_f32_16x16x32_bf16 v[20:23], v[36:39], v[152:155], v[20:23]
  s_waitcnt vmcnt(7)
  buffer_load_dwordx4 v[108:111], v1, s[40:43], s77 offen offset:256 nt
  s_memrealtime s[88:89]
  ds_read_b32 v42, v43 offset:3840
  v_mfma_f32_16x16x32_bf16 v[24:27], v[36:39], v[156:159], v[24:27]
  s_branch L_vd_join
L_vd_l2:
  v_mov_b32_dpp v6, v35 quad_perm:[2,2,2,2] row_mask:0xf bank_mask:0xf
  v_and_b32_dpp v38, v35, v4 quad_perm:[2,2,2,2] row_mask:0xf bank_mask:0xf
  v_and_b32_dpp v39, v35, v5 quad_perm:[2,2,2,2] row_mask:0xf bank_mask:0xf
  v_and_b32_dpp v36, v6, v2 row_half_mirror row_mask:0xf bank_mask:0xf
  v_and_b32_dpp v37, v6, v3 row_half_mirror row_mask:0xf bank_mask:0xf
  s_waitcnt vmcnt(5)
  buffer_load_dwordx4 v[88:91], v1, s[40:43], s76 offen offset:0 nt
  v_mfma_f32_16x16x32_bf16 v[16:19], v[36:39], v[136:139], v[16:19]
  s_waitcnt vmcnt(5)
  buffer_load_dwordx4 v[92:95], v1, s[40:43], s76 offen offset:128 nt
  v_mfma_f32_16x16x32_bf16 v[20:23], v[36:39], v[140:143], v[20:23]
  s_waitcnt vmcnt(5)
  buffer_load_dwordx4 v[96:99], v1, s[40:43], s76 offen offset:256 nt
  v_mfma_f32_16x16x32_bf16 v[24:27], v[36:39], v[144:147], v[24:27]
  v_mov_b32_dpp v6, v35 quad_perm:[3,3,3,3] row_mask:0xf bank_mask:0xf
  v_and_b32_dpp v38, v35, v4 quad_perm:[3,3,3,3] row_mask:0xf bank_mask:0xf
  v_and_b32_dpp v39, v35, v5 quad_perm:[3,3,3,3] row_mask:0xf bank_mask:0xf
  v_and_b32_dpp v36, v6, v2 row_half_mirror row_mask:0xf bank_mask:0xf
  v_and_b32_dpp v37, v6, v3 row_half_mirror row_mask:0xf bank_mask:0xf
  s_waitcnt vmcnt(5)
  buffer_load_dwordx4 v[100:103], v1, s[40:43], s77 offen offset:0 nt
  v_mfma_f32_16x16x32_bf16 v[16:19], v[36:39], v[148:151], v[16:19]
  s_waitcnt vmcnt(5)
  buffer_load_dwordx4 v[104:107], v1, s[40:43], s77 offen offset:128 nt
  v_mfma_f32_16x16x32_bf16 v[20:23], v[36:39], v[152:155], v[20:23]
  s_waitcnt vmcnt(5)
  buffer_load_dwordx4 v[108:111], v1, s[40:43], s77 offen offset:256 nt
  s_memrealtime s[88:89]
  ds_read_b32 v42, v43 offset:3840
  v_mfma_f32_16x16x32_bf16 v[24:27], v[36:39], v[156:159], v[24:27]
  s_branch L_vd_join
L_vd_l1:
  v_mov_b32_dpp v6, v35 quad_perm:[2,2,2,2] row_mask:0xf bank_mask:0xf
  v_and_b32_dpp v38, v35, v4 quad_perm:[2,2,2,2] row_mask:0xf bank_mask:0xf
  v_and_b32_dpp v39, v35, v5 quad_perm:[2,2,2,2] row_mask:0xf bank_mask:0xf
  v_and_b32_dpp v36, v6, v2 row_half_mirror row_mask:0xf bank_mask:0xf
  v_and_b32_dpp v37, v6, v3 row_half_mirror row_mask:0xf bank_mask:0xf
  s_waitcnt vmcnt(4)
  buffer_load_dwordx4 v[88:91], v1, s[40:43], s76 offen offset:0 nt
  v_mfma_f32_16x16x32_bf16 v[16:19], v[36:39], v[136:139], v[16:19]
  s_waitcnt vmcnt(4)
  buffer_load_dwordx4 v[92:95], v1, s[40:43], s76 offen offset:128 nt
  v_mfma_f32_16x16x32_bf16 v[20:23], v[36:39], v[140:143], v[20:23]
  s_waitcnt vmcnt(4)
  buffer_load_dwordx4 v[96:99], v1, s[40:43], s76 offen offset:256 nt
  v_mfma_f32_16x16x32_bf16 v[24:27], v[36:39], v[144:147], v[24:27]
  v_mov_b32_dpp v6, v35 quad_perm:[3,3,3,3] row_mask:0xf bank_mask:0xf
  v_and_b32_dpp v38, v35, v4 quad_perm:[3,3,3,3] row_mask:0xf bank_mask:0xf
  v_and_b32_dpp v39, v35, v5 quad_perm:[3,3,3,3] row_mask:0xf bank_mask:0xf
  v_and_b32_dpp v36, v6, v2 row_half_mirror row_mask:0xf bank_mask:0xf
  v_and_b32_dpp v37, v6, v3 row_half_mirror row_mask:0xf bank_mask:0xf
  s_waitcnt vmcnt(4)
  buffer_load_dwordx4 v[100:103], v1, s[40:43], s77 offen offset:0 nt
  v_mfma_f32_16x16x32_bf16 v[16:19], v[36:39], v[148:151], v[16:19]
  s_waitcnt vmcnt(4)
  buffer_load_dwordx4 v[104:107], v1, s[40:43], s77 offen offset:128 nt
  v_mfma_f32_16x16x32_bf16 v[20:23], v[36:39], v[152:155], v[20:23]
  s_waitcnt vmcnt(4)
  buffer_load_dwordx4 v[108:111], v1, s[40:43], s77 offen offset:256 nt
  s_memrealtime s[88:89]
  ds_read_b32 v42, v43 offset:3840
  v_mfma_f32_16x16x32_bf16 v[24:27], v[36:39], v[156:159], v[24:27]
  s_branch L_vd_join
L_vd_l0:
  v_mov_b32_dpp v6, v35 quad_perm:[2,2,2,2] row_mask:0xf bank_mask:0xf
  v_and_b32_dpp v38, v35, v4 quad_perm:[2,2,2,2] row_mask:0xf bank_mask:0xf
  v_and_b32_dpp v39, v35, v5 quad_perm:[2,2,2,2] row_mask:0xf bank_mask:0xf
  v_and_b32_dpp v36, v6, v2 row_half_mirror row_mask:0xf bank_mask:0xf
  v_and_b32_dpp v37, v6, v3 row_half_mirror row_mask:0xf bank_mask:0xf
  s_waitcnt vmcnt(3)
  buffer_load_dwordx4 v[88:91], v1, s[40:43], s76 offen offset:0 nt
  v_mfma_f32_16x16x32_bf16 v[16:19], v[36:39], v[136:139], v[16:19]
  s_waitcnt vmcnt(3)
  buffer_load_dwordx4 v[92:95], v1, s[40:43], s76 offen offset:128 nt
  v_mfma_f32_16x16x32_bf16 v[20:23], v[36:39], v[140:143], v[20:23]
  s_waitcnt vmcnt(3)
  buffer_load_dwordx4 v[96:99], v1, s[40:43], s76 offen offset:256 nt
  v_mfma_f32_16x16x32_bf16 v[24:27], v[36:39], v[144:147], v[24:27]
  v_mov_b32_dpp v6, v35 quad_perm:[3,3,3,3] row_mask:0xf bank_mask:0xf
  v_and_b32_dpp v38, v35, v4 quad_perm:[3,3,3,3] row_mask:0xf bank_mask:0xf
  v_and_b32_dpp v39, v35, v5 quad_perm:[3,3,3,3] row_mask:0xf bank_mask:0xf
  v_and_b32_dpp v36, v6, v2 row_half_mirror row_mask:0xf bank_mask:0xf
  v_and_b32_dpp v37, v6, v3 row_half_mirror row_mask:0xf bank_mask:0xf
  s_waitcnt vmcnt(3)
  buffer_load_dwordx4 v[100:103], v1, s[40:43], s77 offen offset:0 nt
  v_mfma_f32_16x16x32_bf16 v[16:19], v[36:39], v[148:151], v[16:19]
  s_waitcnt vmcnt(3)
  buffer_load_dwordx4 v[104:107], v1, s[40:43], s77 offen offset:128 nt
  v_mfma_f32_16x16x32_bf16 v[20:23], v[36:39], v[152:155], v[20:23]
  s_waitcnt vmcnt(3)
  buffer_load_dwordx4 v[108:111], v1, s[40:43], s77 offen offset:256 nt
  s_memrealtime s[88:89]
  ds_read_b32 v42, v43 offset:3840
  v_mfma_f32_16x16x32_bf16 v[24:27], v[36:39], v[156:159], v[24:27]
L_vd_join:
  v_mov_b32 v35, v34
  v_mov_b32 v34, v33
  v_mov_b32 v33, v32
  v_mov_b32 v32, v31
  v_mov_b32 v31, v30
  v_mov_b32 v30, v29
  v_mov_b32 v29, v28
  v_add_u32 v40, 6144, v40
  s_add_u32 s14, s14, 1
  s_cmp_lt_u32 s14, 7
  s_cbranch_scc1 L_vloop
  s_mov_b32 exec_lo, 0xff00ff
  s_mov_b32 exec_hi, 0xff00ff00
  ds_write_b128 v40, v[16:19] offset:4096
  ds_write_b128 v40, v[20:23] offset:4352
  ds_write_b128 v40, v[24:27] offset:4608
  s_mov_b64 exec, -1
  v_mov_b32 v44, 14
  v_mov_b32 v45, 15
  ds_write_b32 v48, v44 offset:3908
  v_mov_b32_dpp v6, v35 quad_perm:[0,0,0,0] row_mask:0xf bank_mask:0xf
  v_and_b32_dpp v36, v35, v2 quad_perm:[0,0,0,0] row_mask:0xf bank_mask:0xf
  v_and_b32_dpp v37, v35, v3 quad_perm:[0,0,0,0] row_mask:0xf bank_mask:0xf
  v_and_b32_dpp v38, v6, v4 row_half_mirror row_mask:0xf bank_mask:0xf
  v_and_b32_dpp v39, v6, v5 row_half_mirror row_mask:0xf bank_mask:0xf
  s_waitcnt vmcnt(7)
  buffer_load_dwordx4 v[112:115], v1, s[40:43], s78 offen offset:0 nt
  v_mfma_f32_16x16x32_bf16 v[16:19], v[36:39], v[64:67], 0
  s_waitcnt vmcnt(7)
  buffer_load_dwordx4 v[116:119], v1, s[40:43], s78 offen offset:128 nt
  v_mfma_f32_16x16x32_bf16 v[20:23], v[36:39], v[68:71], 0
  s_waitcnt vmcnt(7)
  buffer_load_dwordx4 v[120:123], v1, s[40:43], s78 offen offset:256 nt
  v_mfma_f32_16x16x32_bf16 v[24:27], v[36:39], v[72:75], 0
  v_mov_b32_dpp v6, v35 quad_perm:[1,1,1,1] row_mask:0xf bank_mask:0xf
  v_and_b32_dpp v36, v35, v2 quad_perm:[1,1,1,1] row_mask:0xf bank_mask:0xf
  v_and_b32_dpp v37, v35, v3 quad_perm:[1,1,1,1] row_mask:0xf bank_mask:0xf
  v_and_b32_dpp v38, v6, v4 row_half_mirror row_mask:0xf bank_mask:0xf
  v_and_b32_dpp v39, v6, v5 row_half_mirror row_mask:0xf bank_mask:0xf
  s_waitcnt vmcnt(7)
  buffer_load_dwordx4 v[124:127], v1, s[40:43], s79 offen offset:0 nt
  v_mfma_f32_16x16x32_bf16 v[16:19], v[36:39], v[76:79], v[16:19]
  s_waitcnt vmcnt(7)
  buffer_load_dwordx4 v[128:131], v1, s[40:43], s79 offen offset:128 nt
  v_mfma_f32_16x16x32_bf16 v[20:23], v[36:39], v[80:83], v[20:23]
  s_waitcnt vmcnt(7)
  buffer_load_dwordx4 v[132:135], v1, s[40:43], s79 offen offset:256 nt
  v_mfma_f32_16x16x32_bf16 v[24:27], v[36:39], v[84:87], v[24:27]
  v_mov_b32_dpp v6, v35 quad_perm:[2,2,2,2] row_mask:0xf bank_mask:0xf
  v_and_b32_dpp v36, v35, v2 quad_perm:[2,2,2,2] row_mask:0xf bank_mask:0xf
  v_and_b32_dpp v37, v35, v3 quad_perm:[2,2,2,2] row_mask:0xf bank_mask:0xf
  v_and_b32_dpp v38, v6, v4 row_half_mirror row_mask:0xf bank_mask:0xf
  v_and_b32_dpp v39, v6, v5 row_half_mirror row_mask:0xf bank_mask:0xf
  s_waitcnt vmcnt(7)
  buffer_load_dwordx4 v[136:139], v1, s[40:43], s80 offen offset:0 nt
  v_mfma_f32_16x16x32_bf16 v[16:19], v[36:39], v[88:91], v[16:19]
  s_waitcnt vmcnt(7)
  buffer_load_dwordx4 v[140:143], v1, s[40:43], s80 offen offset:128 nt
  v_mfma_f32_16x16x32_bf16 v[20:23], v[36:39], v[92:95], v[20:23]
  s_waitcnt vmcnt(7)
  buffer_load_dwordx4 v[144:147], v1, s[40:43], s80 offen offset:256 nt
  v_mfma_f32_16x16x32_bf16 v[24:27], v[36:39], v[96:99], v[24:27]
  v_mov_b32_dpp v6, v35 quad_perm:[3,3,3,3] row_mask:0xf bank_mask:0xf
  v_and_b32_dpp v36, v35, v2 quad_perm:[3,3,3,3] row_mask:0xf bank_mask:0xf
  v_and_b32_dpp v37, v35, v3 quad_perm:[3,3,3,3] row_mask:0xf bank_mask:0xf
  v_and_b32_dpp v38, v6, v4 row_half_mirror row_mask:0xf bank_mask:0xf
  v_and_b32_dpp v39, v6, v5 row_half_mirror row_mask:0xf bank_mask:0xf
  s_waitcnt vmcnt(7)
  buffer_load_dwordx4 v[148:151], v1, s[40:43], s81 offen offset:0 nt
  v_mfma_f32_16x16x32_bf16 v[16:19], v[36:39], v[100:103], v[16:19]
  s_waitcnt vmcnt(7)
  buffer_load_dwordx4 v[152:155], v1, s[40:43], s81 offen offset:128 nt
  v_mfma_f32_16x16x32_bf16 v[20:23], v[36:39], v[104:107], v[20:23]
  s_waitcnt vmcnt(7)
  buffer_load_dwordx4 v[156:159], v1, s[40:43], s81 offen offset:256 nt
  v_mfma_f32_16x16x32_bf16 v[24:27], v[36:39], v[108:111], v[24:27]
  v_mov_b32_dpp v6, v35 quad_perm:[0,0,0,0] row_mask:0xf bank_mask:0xf
  v_and_b32_dpp v38, v35, v4 quad_perm:[0,0,0,0] row_mask:0xf bank_mask:0xf
  v_and_b32_dpp v39, v35, v5 quad_perm:[0,0,0,0] row_mask:0xf bank_mask:0xf
  v_and_b32_dpp v36, v6, v2 row_half_mirror row_mask:0xf bank_mask:0xf
  v_and_b32_dpp v37, v6, v3 row_half_mirror row_mask:0xf bank_mask:0xf
  s_waitcnt vmcnt(11)
  s_nop 0
  v_mfma_f32_16x16x32_bf16 v[16:19], v[36:39], v[112:115], v[16:19]
  s_waitcnt vmcnt(10)
  v_mfma_f32_16x16x32_bf16 v[20:23], v[36:39], v[116:119], v[20:23]
  s_waitcnt vmcnt(9)
  v_mfma_f32_16x16x32_bf16 v[24:27], v[36:39], v[120:123], v[24:27]
  v_mov_b32_dpp v6, v35 quad_perm:[1,1,1,1] row_mask:0xf bank_mask:0xf
  v_and_b32_dpp v38, v35, v4 quad_perm:[1,1,1,1] row_mask:0xf bank_mask:0xf
  v_and_b32_dpp v39, v35, v5 quad_perm:[1,1,1,1] row_mask:0xf bank_mask:0xf
  v_and_b32_dpp v36, v6, v2 row_half_mirror row_mask:0xf bank_mask:0xf
  v_and_b32_dpp v37, v6, v3 row_half_mirror row_mask:0xf bank_mask:0xf
  s_waitcnt vmcnt(8)
  s_nop 0
  v_mfma_f32_16x16x32_bf16 v[16:19], v[36:39], v[124:127], v[16:19]
  s_waitcnt vmcnt(7)
  v_mfma_f32_16x16x32_bf16 v[20:23], v[36:39], v[128:131], v[20:23]
  s_waitcnt vmcnt(6)
  v_mfma_f32_16x16x32_bf16 v[24:27], v[36:39], v[132:135], v[24:27]
  v_mov_b32_dpp v6, v35 quad_perm:[2,2,2,2] row_mask:0xf bank_mask:0xf
  v_and_b32_dpp v38, v35, v4 quad_perm:[2,2,2,2] row_mask:0xf bank_mask:0xf
  v_and_b32_dpp v39, v35, v5 quad_perm:[2,2,2,2] row_mask:0xf bank_mask:0xf
  v_and_b32_dpp v36, v6, v2 row_half_mirror row_mask:0xf bank_mask:0xf
  v_and_b32_dpp v37, v6, v3 row_half_mirror row_mask:0xf bank_mask:0xf
  s_waitcnt vmcnt(5)
  s_nop 0
  v_mfma_f32_16x16x32_bf16 v[16:19], v[36:39], v[136:139], v[16:19]
  s_waitcnt vmcnt(4)
  v_mfma_f32_16x16x32_bf16 v[20:23], v[36:39], v[140:143], v[20:23]
  s_waitcnt vmcnt(3)
  v_mfma_f32_16x16x32_bf16 v[24:27], v[36:39], v[144:147], v[24:27]
  v_mov_b32_dpp v6, v35 quad_perm:[3,3,3,3] row_mask:0xf bank_mask:0xf
  v_and_b32_dpp v38, v35, v4 quad_perm:[3,3,3,3] row_mask:0xf bank_mask:0xf
  v_and_b32_dpp v39, v35, v5 quad_perm:[3,3,3,3] row_mask:0xf bank_mask:0xf
  v_and_b32_dpp v36, v6, v2 row_half_mirror row_mask:0xf bank_mask:0xf
  v_and_b32_dpp v37, v6, v3 row_half_mirror row_mask:0xf bank_mask:0xf
  s_waitcnt vmcnt(2)
  s_nop 0
  v_mfma_f32_16x16x32_bf16 v[16:19], v[36:39], v[148:151], v[16:19]
  ds_write_b32 v43, v44 offset:3860
  s_waitcnt vmcnt(1)
  v_mfma_f32_16x16x32_bf16 v[20:23], v[36:39], v[152:155], v[20:23]
  s_waitcnt vmcnt(0)
  v_mfma_f32_16x16x32_bf16 v[24:27], v[36:39], v[156:159], v[24:27]
  s_mov_b32 exec_lo, 0xff00ff
  s_mov_b32 exec_hi, 0xff00ff00
  s_nop 2
  ds_write_b128 v40, v[16:19] offset:10240
  s_nop 0
  ds_write_b128 v40, v[20:23] offset:10496
  s_nop 0
  ds_write_b128 v40, v[24:27] offset:10752
  ds_write_b32 v48, v45 offset:3908
  s_endpgm
L_service:
  s_mov_b32 s93, 0
  s_cmp_eq_u32 s4, 6
  s_cbranch_scc0 L_noinit
  v_lshlrev_b32 v6, 2, v0
  v_mov_b32 v7, -1
  v_mov_b32 v8, 0
  ds_write_b32 v6, v7 offset:3584
  ds_write_b32 v6, v8 offset:3840
L_noinit:
  v_and_b32 v36, 1, v0
  v_lshlrev_b32 v36, 4, v36
  v_mov_b32 v37, 0xffff
  v_lshlrev_b32 v36, v36, v37
  v_bfe_u32 v37, v0, 1, 2
  v_cmp_eq_u32 vcc, 0, v37
  s_nop 1
  v_cndmask_b32 v2, 0, v36, vcc
  v_cmp_eq_u32 vcc, 1, v37
  s_nop 1
  v_cndmask_b32 v3, 0, v36, vcc
  v_cmp_eq_u32 vcc, 2, v37
  s_nop 1
  v_cndmask_b32 v4, 0, v36, vcc
  v_cmp_eq_u32 vcc, 3, v37
  s_nop 1
  v_cndmask_b32 v5, 0, v36, vcc
  s_mov_b32 s68, 0x3fb8aa3b
  s_mul_i32 s10, s5, 384
  s_lshl_b32 s11, s6, 7
  s_add_u32 s10, s10, s11
  s_lshr_b32 s12, s8, 3
  s_mul_i32 s12, s12, 384
  s_add_u32 s12, s12, s11
  s_mul_i32 s11, s3, 3072
  s_add_u32 s12, s12, s11
  s_add_u32 s12, s12, 655360
  s_lshl_b32 s11, s5, 7
  s_mul_i32 s13, s6, 6144
  s_add_u32 s13, s13, s11
  s_add_u32 s13, s13, 374784
  s_lshl_b32 s77, s3, 2
  s_add_u32 s77, s77, 16
  s_cmp_eq_u32 s4, 4
  s_cselect_b32 s77, s77, 0x1000
  s_movk_i32 s74, 3072
  s_movk_i32 s75, 3072
  s_mov_b32 s78, 1966080
  s_cmp_lt_u32 s6, 3
  s_cselect_b32 s74, 12288, s74
  s_cselect_b32 s75, 1536, s75
  s_cselect_b32 s76, s12, s13
  s_cselect_b32 s77, s77, 0x1000
  s_cselect_b32 s78, 7864320, s78
  s_cselect_b32 s10, s10, s11
  s_waitcnt lgkmcnt(0)
  s_cselect_b32 s30, s22, s30
  s_cselect_b32 s31, s23, s31
  s_cmp_eq_u32 s6, 3
  s_cselect_b32 s30, s28, s30
  s_cselect_b32 s31, s29, s31
  s_sub_u32 s11, s78, s10
  s_add_u32 s40, s30, s10
  s_addc_u32 s41, s31, 0
  s_mov_b32 s42, s11
  s_mov_b32 s43, 0x20000
  s_mov_b32 s60, s16
  s_mov_b32 s61, s17
  s_mov_b32 s62, 2560
  s_mov_b32 s63, 0x20000
  s_mov_b32 s52, s38
  s_mov_b32 s53, s39
  s_mov_b32 s54, 4194304
  s_mov_b32 s55, 0x20000
  s_mov_b32 s56, s36
  s_mov_b32 s57, s37
  s_mov_b32 s58, 256
  s_mov_b32 s59, 0x20000
  s_barrier
  s_cmp_lt_u32 s5, 24
  s_cselect_b32 s91, 5, 3
  s_cmp_lt_u32 s6, s91
  s_cselect_b32 s91, 1, 0
  s_cbranch_scc0 L_roles
  v_mul_u32_u24 v8, 40, v0
  buffer_load_dwordx4 v[88:91], v8, s[60:63], 0 offen
  buffer_load_dwordx4 v[92:95], v8, s[60:63], 0 offen offset:16
  buffer_load_dwordx2 v[96:97], v8, s[60:63], 0 offen offset:32
  v_lshrrev_b32 v6, 3, v0
  v_and_b32 v7, 7, v0
  s_sub_u32 s12, s4, 4
  s_lshl_b32 s10, s12, 3
  v_add_u32 v12, s10, v6
  s_mul_i32 s10, s74, 20
  v_mul_lo_u32 v9, v12, s10
  v_lshl_add_u32 v9, v7, 4, v9
  s_mov_b32 s13, 0
  buffer_load_dwordx4 v[128:131], v9, s[40:43], s13 offen nt
  s_add_u32 s13, s13, s74
  buffer_load_dwordx4 v[132:135], v9, s[40:43], s13 offen nt
  s_add_u32 s13, s13, s74
  buffer_load_dwordx4 v[136:139], v9, s[40:43], s13 offen nt
  s_add_u32 s13, s13, s74
  buffer_load_dwordx4 v[140:143], v9, s[40:43], s13 offen nt
  s_add_u32 s13, s13, s74
  buffer_load_dwordx4 v[144:147], v9, s[40:43], s13 offen nt
  s_add_u32 s13, s13, s74
  buffer_load_dwordx4 v[148:151], v9, s[40:43], s13 offen nt
  s_add_u32 s13, s13, s74
  buffer_load_dwordx4 v[152:155], v9, s[40:43], s13 offen nt
  s_add_u32 s13, s13, s74
  buffer_load_dwordx4 v[156:159], v9, s[40:43], s13 offen nt
  s_add_u32 s13, s13, s74
  v_lshlrev_b32 v12, 2, v12
  v_mov_b32 v13, 0x0c0c0c0c
  s_mov_b32 s10, 0x01000100
  s_mov_b32 s11, 0x03020302
  v_bfi_b32 v40, v2, s10, v13
  v_bfi_b32 v44, v2, s11, v13
  v_bfi_b32 v41, v3, s10, v13
  v_bfi_b32 v45, v3, s11, v13
  v_bfi_b32 v42, v4, s10, v13
  v_bfi_b32 v46, v4, s11, v13
  v_bfi_b32 v43, v5, s10, v13
  v_bfi_b32 v47, v5, s11, v13
  s_mov_b32 s10, 0x3f803f80
  v_mov_b32 v36, 0
  s_waitcnt vmcnt(8)
  v_dot2c_f32_bf16 v36, s10, v88
  v_dot2c_f32_bf16 v36, s10, v89
  v_dot2c_f32_bf16 v36, s10, v90
  v_dot2c_f32_bf16 v36, s10, v91
  v_dot2c_f32_bf16 v36, s10, v92
  v_dot2c_f32_bf16 v36, s10, v93
  v_dot2c_f32_bf16 v36, s10, v94
  v_dot2c_f32_bf16 v36, s10, v95
  v_dot2c_f32_bf16 v36, s10, v96
  v_dot2c_f32_bf16 v36, s10, v97
  s_nop 2
  v_add_f32_dpp v36, v36, v36 quad_perm:[1,0,3,2] row_mask:0xf bank_mask:0xf
  s_nop 1
  v_add_f32_dpp v36, v36, v36 quad_perm:[2,3,0,1] row_mask:0xf bank_mask:0xf
  s_nop 1
  v_add_f32_dpp v36, v36, v36 row_half_mirror row_mask:0xf bank_mask:0xf
  s_nop 1
  v_add_f32_dpp v36, v36, v36 row_mirror row_mask:0xf bank_mask:0xf
  s_nop 1
  v_mov_b32 v38, v36
  s_nop 1
  v_permlane16_swap_b32 v36, v38
  s_nop 1
  v_add_f32 v36, v36, v38
  v_mul_f32 v36, 0x3acccccd, v36
  v_mov_b32 v37, 0
  v_lshlrev_b32 v38, 16, v88
  v_and_b32 v39, 0xffff0000, v88
  v_sub_f32 v38, v38, v36
  v_sub_f32 v39, v39, v36
  v_fmac_f32 v37, v38, v38
  v_fmac_f32 v37, v39, v39
  v_lshlrev_b32 v38, 16, v89
  v_and_b32 v39, 0xffff0000, v89
  v_sub_f32 v38, v38, v36
  v_sub_f32 v39, v39, v36
  v_fmac_f32 v37, v38, v38
  v_fmac_f32 v37, v39, v39
  v_lshlrev_b32 v38, 16, v90
  v_and_b32 v39, 0xffff0000, v90
  v_sub_f32 v38, v38, v36
  v_sub_f32 v39, v39, v36
  v_fmac_f32 v37, v38, v38
  v_fmac_f32 v37, v39, v39
  v_lshlrev_b32 v38, 16, v91
  v_and_b32 v39, 0xffff0000, v91
  v_sub_f32 v38, v38, v36
  v_sub_f32 v39, v39, v36
  v_fmac_f32 v37, v38, v38
  v_fmac_f32 v37, v39, v39
  v_lshlrev_b32 v38, 16, v92
  v_and_b32 v39, 0xffff0000, v92
  v_sub_f32 v38, v38, v36
  v_sub_f32 v39, v39, v36
  v_fmac_f32 v37, v38, v38
  v_fmac_f32 v37, v39, v39
  v_lshlrev_b32 v38, 16, v93
  v_and_b32 v39, 0xffff0000, v93
  v_sub_f32 v38, v38, v36
  v_sub_f32 v39, v39, v36
  v_fmac_f32 v37, v38, v38
  v_fmac_f32 v37, v39, v39
  v_lshlrev_b32 v38, 16, v94
  v_and_b32 v39, 0xffff0000, v94
  v_sub_f32 v38, v38, v36
  v_sub_f32 v39, v39, v36
  v_fmac_f32 v37, v38, v38
  v_fmac_f32 v37, v39, v39
  v_lshlrev_b32 v38, 16, v95
  v_and_b32 v39, 0xffff0000, v95
  v_sub_f32 v38, v38, v36
  v_sub_f32 v39, v39, v36
  v_fmac_f32 v37, v38, v38
  v_fmac_f32 v37, v39, v39
  v_lshlrev_b32 v38, 16, v96
  v_and_b32 v39, 0xffff0000, v96
  v_sub_f32 v38, v38, v36
  v_sub_f32 v39, v39, v36
  v_fmac_f32 v37, v38, v38
  v_fmac_f32 v37, v39, v39
  v_lshlrev_b32 v38, 16, v97
  v_and_b32 v39, 0xffff0000, v97
  v_sub_f32 v38, v38, v36
  v_sub_f32 v39, v39, v36
  v_fmac_f32 v37, v38, v38
  v_fmac_f32 v37, v39, v39
  s_nop 1
  v_add_f32_dpp v37, v37, v37 quad_perm:[1,0,3,2] row_mask:0xf bank_mask:0xf
  s_nop 1
  v_add_f32_dpp v37, v37, v37 quad_perm:[2,3,0,1] row_mask:0xf bank_mask:0xf
  s_nop 1
  v_add_f32_dpp v37, v37, v37 row_half_mirror row_mask:0xf bank_mask:0xf
  s_nop 1
  v_add_f32_dpp v37, v37, v37 row_mirror row_mask:0xf bank_mask:0xf
  s_nop 1
  v_mov_b32 v38, v37
  s_nop 1
  v_permlane16_swap_b32 v37, v38
  s_nop 1
  v_add_f32 v37, v37, v38
  v_mul_f32 v37, 0x3acccccd, v37
  v_cvt_pk_bf16_f32 v36, v36, v36
  v_and_b32 v36, 0xffff0000, v36
  v_cvt_pk_bf16_f32 v37, v37, v37
  v_and_b32 v37, 0xffff0000, v37
  v_add_f32 v37, 0x37280000, v37
  v_cvt_pk_bf16_f32 v37, v37, v37
  v_and_b32 v37, 0xffff0000, v37
  v_sqrt_f32 v37, v37
  s_nop 0
  v_cvt_pk_bf16_f32 v37, v37, v37
  v_and_b32 v37, 0xffff0000, v37
  v_rcp_f32 v37, v37
  buffer_load_dwordx4 v[160:163], v9, s[40:43], s13 offen nt
  s_add_u32 s13, s13, s74
  buffer_load_dwordx4 v[164:167], v9, s[40:43], s13 offen nt
  s_add_u32 s13, s13, s74
  buffer_load_dwordx4 v[168:171], v9, s[40:43], s13 offen nt
  s_add_u32 s13, s13, s74
  buffer_load_dwordx4 v[172:175], v9, s[40:43], s13 offen nt
  s_add_u32 s13, s13, s74
  buffer_load_dwordx4 v[176:179], v9, s[40:43], s13 offen nt
  s_add_u32 s13, s13, s74
  buffer_load_dwordx4 v[180:183], v9, s[40:43], s13 offen nt
  s_add_u32 s13, s13, s74
  v_lshlrev_b32 v38, 16, v88
  v_and_b32 v39, 0xffff0000, v88
  v_sub_f32 v38, v38, v36
  v_sub_f32 v39, v39, v36
  v_cvt_pk_bf16_f32 v39, v38, v39
  v_lshlrev_b32 v38, 16, v39
  v_and_b32 v39, 0xffff0000, v39
  v_mul_f32 v38, v38, v37
  v_mul_f32 v39, v39, v37
  v_cvt_pk_bf16_f32 v88, v38, v39
  ds_bpermute_b32 v16, v12, v88
  ds_bpermute_b32 v26, v12, v88 offset:128
  v_lshlrev_b32 v38, 16, v89
  v_and_b32 v39, 0xffff0000, v89
  v_sub_f32 v38, v38, v36
  v_sub_f32 v39, v39, v36
  v_cvt_pk_bf16_f32 v39, v38, v39
  v_lshlrev_b32 v38, 16, v39
  v_and_b32 v39, 0xffff0000, v39
  v_mul_f32 v38, v38, v37
  v_mul_f32 v39, v39, v37
  v_cvt_pk_bf16_f32 v89, v38, v39
  ds_bpermute_b32 v17, v12, v89
  ds_bpermute_b32 v27, v12, v89 offset:128
  v_lshlrev_b32 v38, 16, v90
  v_and_b32 v39, 0xffff0000, v90
  v_sub_f32 v38, v38, v36
  v_sub_f32 v39, v39, v36
  v_cvt_pk_bf16_f32 v39, v38, v39
  v_lshlrev_b32 v38, 16, v39
  v_and_b32 v39, 0xffff0000, v39
  v_mul_f32 v38, v38, v37
  v_mul_f32 v39, v39, v37
  v_cvt_pk_bf16_f32 v90, v38, v39
  ds_bpermute_b32 v18, v12, v90
  ds_bpermute_b32 v28, v12, v90 offset:128
  v_lshlrev_b32 v38, 16, v91
  v_and_b32 v39, 0xffff0000, v91
  v_sub_f32 v38, v38, v36
  v_sub_f32 v39, v39, v36
  v_cvt_pk_bf16_f32 v39, v38, v39
  v_lshlrev_b32 v38, 16, v39
  v_and_b32 v39, 0xffff0000, v39
  v_mul_f32 v38, v38, v37
  v_mul_f32 v39, v39, v37
  v_cvt_pk_bf16_f32 v91, v38, v39
  ds_bpermute_b32 v19, v12, v91
  ds_bpermute_b32 v29, v12, v91 offset:128
  v_lshlrev_b32 v38, 16, v92
  v_and_b32 v39, 0xffff0000, v92
  v_sub_f32 v38, v38, v36
  v_sub_f32 v39, v39, v36
  v_cvt_pk_bf16_f32 v39, v38, v39
  v_lshlrev_b32 v38, 16, v39
  v_and_b32 v39, 0xffff0000, v39
  v_mul_f32 v38, v38, v37
  v_mul_f32 v39, v39, v37
  v_cvt_pk_bf16_f32 v92, v38, v39
  ds_bpermute_b32 v20, v12, v92
  ds_bpermute_b32 v30, v12, v92 offset:128
  v_lshlrev_b32 v38, 16, v93
  v_and_b32 v39, 0xffff0000, v93
  v_sub_f32 v38, v38, v36
  v_sub_f32 v39, v39, v36
  v_cvt_pk_bf16_f32 v39, v38, v39
  v_lshlrev_b32 v38, 16, v39
  v_and_b32 v39, 0xffff0000, v39
  v_mul_f32 v38, v38, v37
  v_mul_f32 v39, v39, v37
  v_cvt_pk_bf16_f32 v93, v38, v39
  ds_bpermute_b32 v21, v12, v93
  ds_bpermute_b32 v31, v12, v93 offset:128
  v_lshlrev_b32 v38, 16, v94
  v_and_b32 v39, 0xffff0000, v94
  v_sub_f32 v38, v38, v36
  v_sub_f32 v39, v39, v36
  v_cvt_pk_bf16_f32 v39, v38, v39
  v_lshlrev_b32 v38, 16, v39
  v_and_b32 v39, 0xffff0000, v39
  v_mul_f32 v38, v38, v37
  v_mul_f32 v39, v39, v37
  v_cvt_pk_bf16_f32 v94, v38, v39
  ds_bpermute_b32 v22, v12, v94
  ds_bpermute_b32 v32, v12, v94 offset:128
  s_waitcnt lgkmcnt(4)
  v_lshlrev_b32 v38, 16, v95
  v_and_b32 v39, 0xffff0000, v95
  v_sub_f32 v38, v38, v36
  v_sub_f32 v39, v39, v36
  v_cvt_pk_bf16_f32 v39, v38, v39
  v_lshlrev_b32 v38, 16, v39
  v_and_b32 v39, 0xffff0000, v39
  v_mul_f32 v38, v38, v37
  v_mul_f32 v39, v39, v37
  v_cvt_pk_bf16_f32 v95, v38, v39
  ds_bpermute_b32 v23, v12, v95
  ds_bpermute_b32 v33, v12, v95 offset:128
  v_lshlrev_b32 v38, 16, v96
  v_and_b32 v39, 0xffff0000, v96
  v_sub_f32 v38, v38, v36
  v_sub_f32 v39, v39, v36
  v_cvt_pk_bf16_f32 v39, v38, v39
  v_lshlrev_b32 v38, 16, v39
  v_and_b32 v39, 0xffff0000, v39
  v_mul_f32 v38, v38, v37
  v_mul_f32 v39, v39, v37
  v_cvt_pk_bf16_f32 v96, v38, v39
  ds_bpermute_b32 v24, v12, v96
  ds_bpermute_b32 v34, v12, v96 offset:128
  v_lshlrev_b32 v38, 16, v97
  v_and_b32 v39, 0xffff0000, v97
  v_sub_f32 v38, v38, v36
  v_sub_f32 v39, v39, v36
  v_cvt_pk_bf16_f32 v39, v38, v39
  v_lshlrev_b32 v38, 16, v39
  v_and_b32 v39, 0xffff0000, v39
  v_mul_f32 v38, v38, v37
  v_mul_f32 v39, v39, v37
  v_cvt_pk_bf16_f32 v97, v38, v39
  ds_bpermute_b32 v25, v12, v97
  ds_bpermute_b32 v35, v12, v97 offset:128
  buffer_load_dwordx4 v[184:187], v9, s[40:43], s13 offen nt
  s_add_u32 s13, s13, s74
  buffer_load_dwordx4 v[188:191], v9, s[40:43], s13 offen nt
  s_add_u32 s13, s13, s74
  buffer_load_dwordx4 v[192:195], v9, s[40:43], s13 offen nt
  s_add_u32 s13, s13, s74
  buffer_load_dwordx4 v[196:199], v9, s[40:43], s13 offen nt
  s_add_u32 s13, s13, s74
  buffer_load_dwordx4 v[200:203], v9, s[40:43], s13 offen nt
  s_add_u32 s13, s13, s74
  buffer_load_dwordx4 v[204:207], v9, s[40:43], s13 offen nt
  s_add_u32 s13, s13, s74
  v_mov_b32 v10, 0
  buffer_load_dword v10, v10, s[56:59], s77 offen sc1
  v_lshlrev_b32 v11, 4, v7
  v_bfe_u32 v13, v0, 4, 1
  v_lshl_add_u32 v11, v13, 3, v11
  v_lshrrev_b32 v13, 5, v0
  v_mul_u32_u24 v13, s75, v13
  v_add_u32 v11, v11, v13
  s_waitcnt lgkmcnt(0)
  v_perm_b32 v36, v16, v16, v40
  v_perm_b32 v37, v16, v16, v41
  v_perm_b32 v38, v16, v16, v42
  v_perm_b32 v39, v16, v16, v43
  v_perm_b32 v48, v26, v26, v40
  v_perm_b32 v49, v26, v26, v41
  v_perm_b32 v50, v26, v26, v42
  v_perm_b32 v51, v26, v26, v43
  s_waitcnt vmcnt(20)
  v_mfma_f32_16x16x32_bf16 v[64:67], v[36:39], v[128:131], 0
  v_mfma_f32_16x16x32_bf16 v[68:71], v[48:51], v[128:131], 0
  v_perm_b32 v36, v16, v16, v44
  v_perm_b32 v37, v16, v16, v45
  v_perm_b32 v38, v16, v16, v46
  v_perm_b32 v39, v16, v16, v47
  v_perm_b32 v48, v26, v26, v44
  v_perm_b32 v49, v26, v26, v45
  v_perm_b32 v50, v26, v26, v46
  v_perm_b32 v51, v26, v26, v47
  s_waitcnt vmcnt(19)
  v_mfma_f32_16x16x32_bf16 v[64:67], v[36:39], v[132:135], v[64:67]
  v_mfma_f32_16x16x32_bf16 v[68:71], v[48:51], v[132:135], v[68:71]
  v_perm_b32 v36, v17, v17, v40
  v_perm_b32 v37, v17, v17, v41
  v_perm_b32 v38, v17, v17, v42
  v_perm_b32 v39, v17, v17, v43
  v_perm_b32 v48, v27, v27, v40
  v_perm_b32 v49, v27, v27, v41
  v_perm_b32 v50, v27, v27, v42
  v_perm_b32 v51, v27, v27, v43
  s_waitcnt vmcnt(18)
  v_mfma_f32_16x16x32_bf16 v[64:67], v[36:39], v[136:139], v[64:67]
  v_mfma_f32_16x16x32_bf16 v[68:71], v[48:51], v[136:139], v[68:71]
  v_perm_b32 v36, v17, v17, v44
  v_perm_b32 v37, v17, v17, v45
  v_perm_b32 v38, v17, v17, v46
  v_perm_b32 v39, v17, v17, v47
  v_perm_b32 v48, v27, v27, v44
  v_perm_b32 v49, v27, v27, v45
  v_perm_b32 v50, v27, v27, v46
  v_perm_b32 v51, v27, v27, v47
  s_waitcnt vmcnt(17)
  v_mfma_f32_16x16x32_bf16 v[64:67], v[36:39], v[140:143], v[64:67]
  v_mfma_f32_16x16x32_bf16 v[68:71], v[48:51], v[140:143], v[68:71]
  v_perm_b32 v36, v18, v18, v40
  v_perm_b32 v37, v18, v18, v41
  v_perm_b32 v38, v18, v18, v42
  v_perm_b32 v39, v18, v18, v43
  v_perm_b32 v48, v28, v28, v40
  v_perm_b32 v49, v28, v28, v41
  v_perm_b32 v50, v28, v28, v42
  v_perm_b32 v51, v28, v28, v43
  s_waitcnt vmcnt(16)
  v_mfma_f32_16x16x32_bf16 v[64:67], v[36:39], v[144:147], v[64:67]
  v_mfma_f32_16x16x32_bf16 v[68:71], v[48:51], v[144:147], v[68:71]
  v_perm_b32 v36, v18, v18, v44
  v_perm_b32 v37, v18, v18, v45
  v_perm_b32 v38, v18, v18, v46
  v_perm_b32 v39, v18, v18, v47
  v_perm_b32 v48, v28, v28, v44
  v_perm_b32 v49, v28, v28, v45
  v_perm_b32 v50, v28, v28, v46
  v_perm_b32 v51, v28, v28, v47
  s_waitcnt vmcnt(15)
  v_mfma_f32_16x16x32_bf16 v[64:67], v[36:39], v[148:151], v[64:67]
  v_mfma_f32_16x16x32_bf16 v[68:71], v[48:51], v[148:151], v[68:71]
  v_perm_b32 v36, v19, v19, v40
  v_perm_b32 v37, v19, v19, v41
  v_perm_b32 v38, v19, v19, v42
  v_perm_b32 v39, v19, v19, v43
  v_perm_b32 v48, v29, v29, v40
  v_perm_b32 v49, v29, v29, v41
  v_perm_b32 v50, v29, v29, v42
  v_perm_b32 v51, v29, v29, v43
  s_waitcnt vmcnt(14)
  v_mfma_f32_16x16x32_bf16 v[64:67], v[36:39], v[152:155], v[64:67]
  v_mfma_f32_16x16x32_bf16 v[68:71], v[48:51], v[152:155], v[68:71]
  v_perm_b32 v36, v19, v19, v44
  v_perm_b32 v37, v19, v19, v45
  v_perm_b32 v38, v19, v19, v46
  v_perm_b32 v39, v19, v19, v47
  v_perm_b32 v48, v29, v29, v44
  v_perm_b32 v49, v29, v29, v45
  v_perm_b32 v50, v29, v29, v46
  v_perm_b32 v51, v29, v29, v47
  s_waitcnt vmcnt(13)
  v_mfma_f32_16x16x32_bf16 v[64:67], v[36:39], v[156:159], v[64:67]
  v_mfma_f32_16x16x32_bf16 v[68:71], v[48:51], v[156:159], v[68:71]
  v_perm_b32 v36, v20, v20, v40
  v_perm_b32 v37, v20, v20, v41
  v_perm_b32 v38, v20, v20, v42
  v_perm_b32 v39, v20, v20, v43
  v_perm_b32 v48, v30, v30, v40
  v_perm_b32 v49, v30, v30, v41
  v_perm_b32 v50, v30, v30, v42
  v_perm_b32 v51, v30, v30, v43
  s_waitcnt vmcnt(12)
  v_mfma_f32_16x16x32_bf16 v[64:67], v[36:39], v[160:163], v[64:67]
  v_mfma_f32_16x16x32_bf16 v[68:71], v[48:51], v[160:163], v[68:71]
  v_perm_b32 v36, v20, v20, v44
  v_perm_b32 v37, v20, v20, v45
  v_perm_b32 v38, v20, v20, v46
  v_perm_b32 v39, v20, v20, v47
  v_perm_b32 v48, v30, v30, v44
  v_perm_b32 v49, v30, v30, v45
  v_perm_b32 v50, v30, v30, v46
  v_perm_b32 v51, v30, v30, v47
  s_waitcnt vmcnt(11)
  v_mfma_f32_16x16x32_bf16 v[64:67], v[36:39], v[164:167], v[64:67]
  v_mfma_f32_16x16x32_bf16 v[68:71], v[48:51], v[164:167], v[68:71]
  v_perm_b32 v36, v21, v21, v40
  v_perm_b32 v37, v21, v21, v41
  v_perm_b32 v38, v21, v21, v42
  v_perm_b32 v39, v21, v21, v43
  v_perm_b32 v48, v31, v31, v40
  v_perm_b32 v49, v31, v31, v41
  v_perm_b32 v50, v31, v31, v42
  v_perm_b32 v51, v31, v31, v43
  s_waitcnt vmcnt(10)
  v_mfma_f32_16x16x32_bf16 v[64:67], v[36:39], v[168:171], v[64:67]
  v_mfma_f32_16x16x32_bf16 v[68:71], v[48:51], v[168:171], v[68:71]
  v_perm_b32 v36, v21, v21, v44
  v_perm_b32 v37, v21, v21, v45
  v_perm_b32 v38, v21, v21, v46
  v_perm_b32 v39, v21, v21, v47
  v_perm_b32 v48, v31, v31, v44
  v_perm_b32 v49, v31, v31, v45
  v_perm_b32 v50, v31, v31, v46
  v_perm_b32 v51, v31, v31, v47
  s_waitcnt vmcnt(9)
  v_mfma_f32_16x16x32_bf16 v[64:67], v[36:39], v[172:175], v[64:67]
  v_mfma_f32_16x16x32_bf16 v[68:71], v[48:51], v[172:175], v[68:71]
  v_perm_b32 v36, v22, v22, v40
  v_perm_b32 v37, v22, v22, v41
  v_perm_b32 v38, v22, v22, v42
  v_perm_b32 v39, v22, v22, v43
  v_perm_b32 v48, v32, v32, v40
  v_perm_b32 v49, v32, v32, v41
  v_perm_b32 v50, v32, v32, v42
  v_perm_b32 v51, v32, v32, v43
  s_waitcnt vmcnt(8)
  v_mfma_f32_16x16x32_bf16 v[64:67], v[36:39], v[176:179], v[64:67]
  v_mfma_f32_16x16x32_bf16 v[68:71], v[48:51], v[176:179], v[68:71]
  v_perm_b32 v36, v22, v22, v44
  v_perm_b32 v37, v22, v22, v45
  v_perm_b32 v38, v22, v22, v46
  v_perm_b32 v39, v22, v22, v47
  v_perm_b32 v48, v32, v32, v44
  v_perm_b32 v49, v32, v32, v45
  v_perm_b32 v50, v32, v32, v46
  v_perm_b32 v51, v32, v32, v47
  s_waitcnt vmcnt(7)
  v_mfma_f32_16x16x32_bf16 v[64:67], v[36:39], v[180:183], v[64:67]
  v_mfma_f32_16x16x32_bf16 v[68:71], v[48:51], v[180:183], v[68:71]
  v_perm_b32 v36, v23, v23, v40
  v_perm_b32 v37, v23, v23, v41
  v_perm_b32 v38, v23, v23, v42
  v_perm_b32 v39, v23, v23, v43
  v_perm_b32 v48, v33, v33, v40
  v_perm_b32 v49, v33, v33, v41
  v_perm_b32 v50, v33, v33, v42
  v_perm_b32 v51, v33, v33, v43
  s_waitcnt vmcnt(6)
  v_mfma_f32_16x16x32_bf16 v[64:67], v[36:39], v[184:187], v[64:67]
  v_mfma_f32_16x16x32_bf16 v[68:71], v[48:51], v[184:187], v[68:71]
  v_perm_b32 v36, v23, v23, v44
  v_perm_b32 v37, v23, v23, v45
  v_perm_b32 v38, v23, v23, v46
  v_perm_b32 v39, v23, v23, v47
  v_perm_b32 v48, v33, v33, v44
  v_perm_b32 v49, v33, v33, v45
  v_perm_b32 v50, v33, v33, v46
  v_perm_b32 v51, v33, v33, v47
  s_waitcnt vmcnt(5)
  v_mfma_f32_16x16x32_bf16 v[64:67], v[36:39], v[188:191], v[64:67]
  v_mfma_f32_16x16x32_bf16 v[68:71], v[48:51], v[188:191], v[68:71]
  v_perm_b32 v36, v24, v24, v40
  v_perm_b32 v37, v24, v24, v41
  v_perm_b32 v38, v24, v24, v42
  v_perm_b32 v39, v24, v24, v43
  v_perm_b32 v48, v34, v34, v40
  v_perm_b32 v49, v34, v34, v41
  v_perm_b32 v50, v34, v34, v42
  v_perm_b32 v51, v34, v34, v43
  s_waitcnt vmcnt(4)
  v_mfma_f32_16x16x32_bf16 v[64:67], v[36:39], v[192:195], v[64:67]
  v_mfma_f32_16x16x32_bf16 v[68:71], v[48:51], v[192:195], v[68:71]
  v_perm_b32 v36, v24, v24, v44
  v_perm_b32 v37, v24, v24, v45
  v_perm_b32 v38, v24, v24, v46
  v_perm_b32 v39, v24, v24, v47
  v_perm_b32 v48, v34, v34, v44
  v_perm_b32 v49, v34, v34, v45
  v_perm_b32 v50, v34, v34, v46
  v_perm_b32 v51, v34, v34, v47
  s_waitcnt vmcnt(3)
  v_mfma_f32_16x16x32_bf16 v[64:67], v[36:39], v[196:199], v[64:67]
  v_mfma_f32_16x16x32_bf16 v[68:71], v[48:51], v[196:199], v[68:71]
  v_perm_b32 v36, v25, v25, v40
  v_perm_b32 v37, v25, v25, v41
  v_perm_b32 v38, v25, v25, v42
  v_perm_b32 v39, v25, v25, v43
  v_perm_b32 v48, v35, v35, v40
  v_perm_b32 v49, v35, v35, v41
  v_perm_b32 v50, v35, v35, v42
  v_perm_b32 v51, v35, v35, v43
  s_waitcnt vmcnt(2)
  v_mfma_f32_16x16x32_bf16 v[64:67], v[36:39], v[200:203], v[64:67]
  v_mfma_f32_16x16x32_bf16 v[68:71], v[48:51], v[200:203], v[68:71]
  v_perm_b32 v36, v25, v25, v44
  v_perm_b32 v37, v25, v25, v45
  v_perm_b32 v38, v25, v25, v46
  v_perm_b32 v39, v25, v25, v47
  v_perm_b32 v48, v35, v35, v44
  v_perm_b32 v49, v35, v35, v45
  v_perm_b32 v50, v35, v35, v46
  v_perm_b32 v51, v35, v35, v47
  s_waitcnt vmcnt(1)
  v_mfma_f32_16x16x32_bf16 v[64:67], v[36:39], v[204:207], v[64:67]
  v_mfma_f32_16x16x32_bf16 v[68:71], v[48:51], v[204:207], v[68:71]
  s_lshl_b32 s10, s12, 10
  v_lshlrev_b32 v13, 4, v0
  v_add_u32 v13, s10, v13
  v_mov_b32 v14, 1
  v_mov_b32 v12, 0
  s_nop 3
  v_permlane32_swap_b32 v64, v68
  v_permlane32_swap_b32 v65, v69
  v_permlane32_swap_b32 v66, v70
  v_permlane32_swap_b32 v67, v71
  v_add_f32_dpp v64, v68, v64 row_ror:8 row_mask:0xf bank_mask:0xf
  v_add_f32_dpp v65, v69, v65 row_ror:8 row_mask:0xf bank_mask:0xf
  v_add_f32_dpp v66, v70, v66 row_ror:8 row_mask:0xf bank_mask:0xf
  v_add_f32_dpp v67, v71, v67 row_ror:8 row_mask:0xf bank_mask:0xf
  s_cmp_eq_u32 s4, 4
  s_cbranch_scc1 L_cp_sum
  ds_write_b128 v13, v[64:67] offset:59392
  s_mov_b64 exec, 1
  ds_add_u32 v12, v14 offset:3872
  s_mov_b64 exec, -1
  s_waitcnt vmcnt(0)
  s_branch L_roles
L_cp_sum:
  s_mov_b32 s15, 0
L_cpw:
  ds_read_b32 v14, v12 offset:3872
  s_waitcnt lgkmcnt(0)
  v_cmp_gt_u32 vcc, 3, v14
  s_cbranch_vccz L_cpw_ok
  s_sleep 1
  s_add_u32 s15, s15, 1
  s_cmp_lt_u32 s15, 1000000
  s_cbranch_scc1 L_cpw
L_cpw_ok:
  ds_read_b128 v[44:47], v13 offset:60416
  ds_read_b128 v[48:51], v13 offset:61440
  ds_read_b128 v[52:55], v13 offset:62464
  s_waitcnt lgkmcnt(2)
  v_add_f32 v64, v64, v44
  v_add_f32 v65, v65, v45
  v_add_f32 v66, v66, v46
  v_add_f32 v67, v67, v47
  s_waitcnt lgkmcnt(1)
  v_add_f32 v64, v64, v48
  v_add_f32 v65, v65, v49
  v_add_f32 v66, v66, v50
  v_add_f32 v67, v67, v51
  s_waitcnt lgkmcnt(0)
  v_add_f32 v64, v64, v52
  v_add_f32 v65, v65, v53
  v_add_f32 v66, v66, v54
  v_add_f32 v67, v67, v55
  v_cvt_pk_bf16_f32 v64, v64, v65
  v_cvt_pk_bf16_f32 v65, v66, v67
  v_min_u32 v64, -2, v64
  v_min_u32 v65, -2, v65
  s_cmp_lt_u32 s6, 3
  s_cbranch_scc0 L_cp_st
  s_waitcnt vmcnt(0)
  v_cmp_eq_u32 vcc, 0, v10
  s_cbranch_vccz L_cp_st
  s_lshl_b32 s10, s3, 2
  s_mov_b32 s15, 0
L_x0s:
  v_mov_b32 v14, 0
  buffer_load_dword v14, v14, s[56:59], s10 offen offset:16 sc1
  s_waitcnt vmcnt(0)
  v_cmp_eq_u32 vcc, 0, v14
  s_cbranch_vccz L_x0s_ok
  s_sleep 8
  s_add_u32 s15, s15, 1
  s_cmp_lt_u32 s15, 142292
  s_cbranch_scc1 L_x0s
L_x0s_ok:
L_cp_st:
  s_mov_b32 exec_lo, 0xff00ff
  s_mov_b32 exec_hi, 0xff00ff
  buffer_store_dwordx2 v[64:65], v11, s[52:55], s76 offen sc1
  s_mov_b64 exec, -1
L_roles:
  s_cmp_eq_u32 s4, 7
  s_cbranch_scc1 L_x3
  s_cmp_eq_u32 s4, 6
  s_cbranch_scc1 L_x2
  s_cmp_eq_u32 s4, 5
  s_cbranch_scc1 L_x1
  v_mov_b32 v13, 0
  v_mov_b32 v14, 1
  ds_write_b32 v13, v14 offset:3876
  s_waitcnt vmcnt(0)
  s_mov_b64 exec, 1
  ds_add_u32 v13, v14 offset:3848
  s_mov_b64 exec, -1
  s_cmp_lt_u32 s6, 5
  s_cbranch_scc1 L_oproj
  s_cmp_lt_u32 s6, 6
  s_cbranch_scc1 L_final
  s_branch L_bstage
L_x1:
  s_cmp_eq_u32 s7, 245
  s_cbranch_scc0 L_x1_go
  v_lshlrev_b32 v6, 7, v0
  v_mov_b32 v112, 0
  v_mov_b32 v113, 0
  v_mov_b32 v114, 0
  s_mov_b32 s10, 589824
  buffer_store_dwordx3 v[112:114], v6, s[52:55], s10 offen sc1
  s_mov_b32 s10, 598016
  buffer_store_dwordx3 v[112:114], v6, s[52:55], s10 offen sc1
  s_mov_b32 s10, 606208
  buffer_store_dwordx3 v[112:114], v6, s[52:55], s10 offen sc1
  s_mov_b32 s10, 614400
  buffer_store_dwordx3 v[112:114], v6, s[52:55], s10 offen sc1
  s_waitcnt vmcnt(0)
  v_mov_b32 v13, 0
  v_mov_b32 v14, 1
  s_mov_b64 exec, 1
  buffer_store_dword v14, v13, s[56:59], 0 offen offset:0 sc1
  s_mov_b64 exec, -1
L_x1_go:
  s_cmp_eq_u32 s8, 5
  s_cbranch_scc0 L_x1_go2
  v_mov_b32 v116, -1
  v_mov_b32 v117, -1
  v_mov_b32 v118, -1
  v_mov_b32 v119, -1
  v_lshlrev_b32 v7, 4, v0
  s_mul_i32 s10, s3, 3072
  s_add_u32 s10, s10, 655360
  buffer_store_dwordx4 v[116:119], v7, s[52:55], s10 offen offset:0 sc1
  buffer_store_dwordx4 v[116:119], v7, s[52:55], s10 offen offset:1024 sc1
  buffer_store_dwordx4 v[116:119], v7, s[52:55], s10 offen offset:2048 sc1
  s_lshl_b32 s10, s3, 2
  s_waitcnt vmcnt(0)
  v_mov_b32 v13, 0
  v_mov_b32 v14, 1
  s_mov_b64 exec, 1
  buffer_store_dword v14, v13, s[56:59], s10 offen offset:16 sc1
  s_mov_b64 exec, -1
L_x1_go2:
  v_mov_b32 v12, 0
  s_mov_b32 s15, 0
L_x1e:
  ds_read_b32 v13, v12 offset:3844
  s_waitcnt lgkmcnt(0)
  v_cmp_gt_u32 vcc, 1, v13
  s_cbranch_vccz L_x1e_ok
  s_sleep 32
  s_add_u32 s15, s15, 1
  s_cmp_lt_u32 s15, 67669
  s_cbranch_scc1 L_x1e
L_x1e_ok:
L_x1_rpt:
  v_mov_b32 v12, 0
  s_mov_b32 s15, 0
L_x1c:
  ds_read_b32 v13, v12 offset:3848
  s_waitcnt lgkmcnt(0)
  v_cmp_gt_u32 vcc, 2, v13
  s_cbranch_vccz L_x1c_ok
  s_sleep 16
  s_add_u32 s15, s15, 1
  s_cmp_lt_u32 s15, 130434
  s_cbranch_scc1 L_x1c
L_x1c_ok:
  s_mov_b32 s15, 0
L_x1s:
  v_mov_b32 v13, 0
  buffer_load_dword v13, v13, s[56:59], 0 offen offset:0 sc1
  s_waitcnt vmcnt(0)
  v_cmp_eq_u32 vcc, 0, v13
  s_cbranch_vccz L_x1s_ok
  s_sleep 64
  s_add_u32 s15, s15, 1
  s_cmp_lt_u32 s15, 31331
  s_cbranch_scc1 L_x1s
L_x1s_ok:
  s_lshl_b32 s10, s7, 7
  s_add_u32 s10, s10, 589824
  s_getreg_b32 s11, hwreg(HW_REG_XCC_ID)
  s_lshr_b32 s12, s11, 12
  s_and_b32 s12, s12, 0xf0
  s_and_b32 s11, s11, 0xf
  s_or_b32 s11, s11, s12
  s_lshl_b32 s11, s11, 8
  s_or_b32 s11, s11, 3
  v_mov_b32 v13, 0
  v_mov_b32 v14, s11
  s_mov_b64 exec, 1
  buffer_store_dword v14, v13, s[52:55], s10 offen offset:0 sc1
  s_mov_b64 exec, -1
  s_cmp_lt_u32 s6, 5
  s_cbranch_scc1 L_oproj2
  s_cmp_eq_u32 s7, 245
  s_cbranch_scc1 L_coord
  s_cmp_eq_u32 s7, 253
  s_cbranch_scc1 L_coord2
  s_cmp_eq_u32 s7, 237
  s_cbranch_scc1 L_lagc
  s_cmp_eq_u32 s8, 5
  s_cbranch_scc1 L_mlm
  s_branch L_fin
L_mlm:
  s_mov_b32 s15, 0
L_mwa:
  ds_read_b32 v13, v12 offset:3908
  s_waitcnt lgkmcnt(0)
  v_cmp_gt_u32 vcc, 7, v13
  s_cbranch_vccz L_mwa_ok
  s_sleep 32
  s_add_u32 s15, s15, 1
  s_cmp_lt_u32 s15, 67669
  s_cbranch_scc1 L_mwa
L_mwa_ok:
  s_mov_b32 s15, 0
L_mwb:
  v_mov_b32 v13, 0
  buffer_load_dword v13, v13, s[56:59], 0 offen offset:128 sc1
  s_waitcnt vmcnt(0)
  v_cmp_eq_u32 vcc, 0, v13
  s_cbranch_vccz L_mwb_ok
  s_sleep 64
  s_add_u32 s15, s15, 1
  s_cmp_lt_u32 s15, 31331
  s_cbranch_scc1 L_mwb
L_mwb_ok:
  v_readfirstlane_b32 s69, v13
  s_and_b32 s10, s3, 3
  s_lshl_b32 s10, s10, 3
  s_lshr_b32 s11, s3, 2
  s_add_u32 s10, s10, s11
  s_lshr_b32 s69, s69, s10
  s_and_b32 s69, s69, 1
  v_lshrrev_b32 v6, 2, v0
  v_lshlrev_b32 v6, 7, v6
  v_and_b32 v14, 3, v0
  v_lshl_add_u32 v6, v14, 4, v6
  s_lshl_b32 s10, s3, 12
  s_add_u32 s10, s10, 622592
  s_sleep 80
  s_mov_b32 s15, 0
L_gml:
  buffer_load_dwordx4 v[116:119], v6, s[52:55], s10 offen sc1
  buffer_load_dwordx4 v[120:123], v6, s[52:55], s10 offen offset:2048 sc1
  s_waitcnt vmcnt(0)
  v_max_u32 v14, v116, v117
  v_max3_u32 v14, v118, v119, v14
  v_max3_u32 v14, v120, v121, v14
  v_max3_u32 v14, v122, v123, v14
  v_cmp_eq_u32 vcc, -1, v14
  s_cbranch_vccz L_gml_ok
  s_mov_b64 exec, vcc
  s_sleep 32
  s_add_u32 s15, s15, 1
  s_cmp_lt_u32 s15, 56514
  s_cbranch_scc1 L_gml
L_gml_ok:
  s_mov_b64 exec, -1
  v_max_f32 v64, v116, v120
  v_max_f32 v66, v118, v122
  s_nop 1
  v_max_f32_dpp v64, v64, v64 row_ror:4 row_mask:0xf bank_mask:0xf
  v_max_f32_dpp v66, v66, v66 row_ror:4 row_mask:0xf bank_mask:0xf
  s_nop 0
  v_max_f32_dpp v64, v64, v64 row_ror:8 row_mask:0xf bank_mask:0xf
  v_max_f32_dpp v66, v66, v66 row_ror:8 row_mask:0xf bank_mask:0xf
  s_nop 0
  v_mov_b32 v14, v64
  s_nop 1
  v_permlane16_swap_b32 v64, v14
  s_nop 1
  v_max_f32 v64, v64, v14
  v_mov_b32 v14, v64
  s_nop 1
  v_permlane32_swap_b32 v64, v14
  s_nop 1
  v_max_f32 v64, v64, v14
  v_mov_b32 v14, v66
  s_nop 1
  v_permlane16_swap_b32 v66, v14
  s_nop 1
  v_max_f32 v66, v66, v14
  v_mov_b32 v14, v66
  s_nop 1
  v_permlane32_swap_b32 v66, v14
  s_nop 1
  v_max_f32 v66, v66, v14
  v_sub_f32 v116, v116, v64
  v_mul_f32 v116, s68, v116
  v_exp_f32 v116, v116
  v_sub_f32 v120, v120, v64
  v_mul_f32 v120, s68, v120
  v_exp_f32 v120, v120
  v_sub_f32 v118, v118, v66
  v_mul_f32 v118, s68, v118
  v_exp_f32 v118, v118
  v_sub_f32 v122, v122, v66
  v_mul_f32 v122, s68, v122
  v_exp_f32 v122, v122
  s_nop 0
  v_mul_f32 v65, v116, v117
  v_fmac_f32 v65, v120, v121
  v_mul_f32 v67, v118, v119
  v_fmac_f32 v67, v122, v123
  s_nop 1
  v_add_f32_dpp v65, v65, v65 row_ror:4 row_mask:0xf bank_mask:0xf
  v_add_f32_dpp v67, v67, v67 row_ror:4 row_mask:0xf bank_mask:0xf
  s_nop 0
  v_add_f32_dpp v65, v65, v65 row_ror:8 row_mask:0xf bank_mask:0xf
  v_add_f32_dpp v67, v67, v67 row_ror:8 row_mask:0xf bank_mask:0xf
  s_nop 0
  v_mov_b32 v14, v65
  s_nop 1
  v_permlane16_swap_b32 v65, v14
  s_nop 1
  v_add_f32 v65, v65, v14
  v_mov_b32 v14, v65
  s_nop 1
  v_permlane32_swap_b32 v65, v14
  s_nop 1
  v_add_f32 v65, v65, v14
  v_mov_b32 v14, v67
  s_nop 1
  v_permlane16_swap_b32 v67, v14
  s_nop 1
  v_add_f32 v67, v67, v14
  v_mov_b32 v14, v67
  s_nop 1
  v_permlane32_swap_b32 v67, v14
  s_nop 1
  v_add_f32 v67, v67, v14
  v_min_u32 v64, -2, v64
  v_min_u32 v65, -2, v65
  v_min_u32 v66, -2, v66
  v_min_u32 v67, -2, v67
  v_lshlrev_b32 v7, 4, v0
  s_lshl_b32 s10, s3, 7
  s_add_u32 s10, s10, 688128
  s_mov_b64 exec, 15
  s_cmp_eq_u32 s69, 0
  s_cbranch_scc0 L_mgs_far
  buffer_store_dwordx4 v[64:67], v7, s[52:55], s10 offen
  s_branch L_mgs_done
L_mgs_far:
  buffer_store_dwordx4 v[64:67], v7, s[52:55], s10 offen sc1
L_mgs_done:
  s_mov_b64 exec, -1
  s_branch L_fin
L_bstage:
  v_and_b32 v6, 15, v0
  v_lshrrev_b32 v7, 4, v0
  s_lshl_b32 s12, s5, 1
  s_add_u32 s12, s12, s6
  s_sub_u32 s12, s12, 6
  s_mul_i32 s13, s12, 205
  s_lshr_b32 s13, s13, 10
  s_mul_i32 s10, s13, 5
  s_sub_u32 s11, s12, s10
  v_mul_u32_u24 v8, 40960, v7
  v_lshl_add_u32 v8, v6, 4, v8
  s_lshl_b32 s11, s11, 8
  v_add_u32 v8, s11, v8
  s_mul_i32 s10, s13, 163840
  s_cmp_lt_u32 s12, 60
  s_cselect_b32 s11, 163840, 0
  s_cselect_b32 s10, s10, 0
  s_lshl_b32 s75, s12, 10
  s_add_u32 s75, s75, 917504
  s_add_u32 s40, s32, s10
  s_addc_u32 s41, s33, 0
  s_mov_b32 s42, s11
  s_mov_b32 s43, 0x20000
  s_mov_b32 s10, 0
  buffer_load_dwordx4 v[128:131], v8, s[40:43], s10 offen offset:0 nt
  buffer_load_dwordx4 v[132:135], v8, s[40:43], s10 offen offset:1280 nt
  buffer_load_dwordx4 v[136:139], v8, s[40:43], s10 offen offset:2560 nt
  s_add_u32 s10, s10, 3840
  buffer_load_dwordx4 v[140:143], v8, s[40:43], s10 offen offset:0 nt
  buffer_load_dwordx4 v[144:147], v8, s[40:43], s10 offen offset:1280 nt
  buffer_load_dwordx4 v[148:151], v8, s[40:43], s10 offen offset:2560 nt
  s_add_u32 s10, s10, 3840
  buffer_load_dwordx4 v[152:155], v8, s[40:43], s10 offen offset:0 nt
  buffer_load_dwordx4 v[156:159], v8, s[40:43], s10 offen offset:1280 nt
  buffer_load_dwordx4 v[160:163], v8, s[40:43], s10 offen offset:2560 nt
  s_add_u32 s10, s10, 3840
  buffer_load_dwordx4 v[164:167], v8, s[40:43], s10 offen offset:0 nt
  buffer_load_dwordx4 v[168:171], v8, s[40:43], s10 offen offset:1280 nt
  buffer_load_dwordx4 v[172:175], v8, s[40:43], s10 offen offset:2560 nt
  s_add_u32 s10, s10, 3840
  buffer_load_dwordx4 v[176:179], v8, s[40:43], s10 offen offset:0 nt
  buffer_load_dwordx4 v[180:183], v8, s[40:43], s10 offen offset:1280 nt
  buffer_load_dwordx4 v[184:187], v8, s[40:43], s10 offen offset:2560 nt
  s_add_u32 s10, s10, 3840
  buffer_load_dwordx4 v[188:191], v8, s[40:43], s10 offen offset:0 nt
  buffer_load_dwordx4 v[192:195], v8, s[40:43], s10 offen offset:1280 nt
  buffer_load_dwordx4 v[196:199], v8, s[40:43], s10 offen offset:2560 nt
  s_add_u32 s10, s10, 3840
  buffer_load_dwordx4 v[200:203], v8, s[40:43], s10 offen offset:0 nt
  buffer_load_dwordx4 v[204:207], v8, s[40:43], s10 offen offset:1280 nt
  buffer_load_dwordx4 v[208:211], v8, s[40:43], s10 offen offset:2560 nt
  s_add_u32 s10, s10, 3840
  buffer_load_dwordx4 v[212:215], v8, s[40:43], s10 offen offset:0 nt
  buffer_load_dwordx4 v[216:219], v8, s[40:43], s10 offen offset:1280 nt
  buffer_load_dwordx4 v[220:223], v8, s[40:43], s10 offen offset:2560 nt
  s_add_u32 s10, s10, 3840
  buffer_load_dwordx4 v[224:227], v8, s[40:43], s10 offen offset:0 nt
  buffer_load_dwordx4 v[228:231], v8, s[40:43], s10 offen offset:1280 nt
  buffer_load_dwordx4 v[232:235], v8, s[40:43], s10 offen offset:2560 nt
  s_add_u32 s10, s10, 3840
  buffer_load_dwordx4 v[236:239], v8, s[40:43], s10 offen offset:0 nt
  buffer_load_dwordx4 v[240:243], v8, s[40:43], s10 offen offset:1280 nt
  buffer_load_dwordx4 v[244:247], v8, s[40:43], s10 offen offset:2560 nt
  s_add_u32 s10, s10, 3840
  buffer_load_dwordx4 v[248:251], v8, s[40:43], s10 offen offset:0 nt
  buffer_load_dwordx4 v[252:255], v8, s[40:43], s10 offen offset:1280 nt
  v_lshrrev_b32 v9, 3, v6
  v_mul_u32_u24 v9, 3072, v9
  v_lshl_add_u32 v9, v7, 6, v9
  s_lshl_b32 s10, s13, 8
  s_add_u32 s10, s10, 393216
  v_add_u32 v9, s10, v9
  s_movk_i32 s74, 6144
  v_and_b32 v10, 15, v0
  v_lshlrev_b32 v10, 5, v10
  v_and_b32 v13, 16, v0
  v_add_u32 v10, v10, v13
  v_lshrrev_b32 v13, 5, v0
  v_lshl_add_u32 v10, v13, 9, v10
  v_mov_b32 v12, 0
  s_mov_b32 s15, 0
L_be:
  ds_read_b32 v13, v12 offset:3908
  s_waitcnt lgkmcnt(0)
  v_cmp_gt_u32 vcc, 5, v13
  s_cbranch_vccz L_be_ok
  s_sleep 32
  s_add_u32 s15, s15, 1
  s_cmp_lt_u32 s15, 67669
  s_cbranch_scc1 L_be
L_be_ok:
  s_mov_b32 s15, 0
L_bg:
  v_mov_b32 v13, 0
  buffer_load_dword v13, v13, s[56:59], 0 offen offset:128 sc1
  s_waitcnt vmcnt(0)
  v_cmp_eq_u32 vcc, 0, v13
  s_cbranch_vccz L_bg_ok
  s_sleep 64
  s_add_u32 s15, s15, 1
  s_cmp_lt_u32 s15, 31331
  s_cbranch_scc1 L_bg
L_bg_ok:
  s_cmp_lt_u32 s12, 60
  s_cbranch_scc0 L_b_rpt
  buffer_load_dwordx4 v[72:75], v9, s[52:55], 0 offen offset:0 sc1
  buffer_load_dwordx4 v[88:91], v9, s[52:55], s74 offen offset:0 sc1
  buffer_load_dwordx4 v[76:79], v9, s[52:55], 0 offen offset:16 sc1
  buffer_load_dwordx4 v[92:95], v9, s[52:55], s74 offen offset:16 sc1
  buffer_load_dwordx4 v[80:83], v9, s[52:55], 0 offen offset:32 sc1
  buffer_load_dwordx4 v[96:99], v9, s[52:55], s74 offen offset:32 sc1
  buffer_load_dwordx4 v[84:87], v9, s[52:55], 0 offen offset:48 sc1
  buffer_load_dwordx4 v[100:103], v9, s[52:55], s74 offen offset:48 sc1
  s_waitcnt vmcnt(0)
  v_lshlrev_b32 v40, 16, v72
  v_lshlrev_b32 v41, 16, v88
  v_mul_f32 v40, s68, v40
  v_exp_f32 v40, -v40
  s_nop 0
  v_add_f32 v40, 1.0, v40
  v_rcp_f32 v40, v40
  s_nop 0
  v_cvt_pk_bf16_f32 v40, v40, v40
  v_and_b32 v40, 0xffff0000, v40
  v_mul_f32 v40, v40, v41
  v_cvt_pk_bf16_f32 v40, v40, v40
  v_and_b32 v36, v40, v2
  v_and_b32 v37, v40, v3
  v_and_b32 v38, v40, v4
  v_and_b32 v39, v40, v5
  s_nop 1
  v_mfma_f32_16x16x32_bf16 v[64:67], v[36:39], v[128:131], 0
  v_and_b32 v40, 0xffff0000, v72
  v_and_b32 v41, 0xffff0000, v88
  v_mul_f32 v40, s68, v40
  v_exp_f32 v40, -v40
  s_nop 0
  v_add_f32 v40, 1.0, v40
  v_rcp_f32 v40, v40
  s_nop 0
  v_cvt_pk_bf16_f32 v40, v40, v40
  v_and_b32 v40, 0xffff0000, v40
  v_mul_f32 v40, v40, v41
  v_cvt_pk_bf16_f32 v40, v40, v40
  v_and_b32 v36, v40, v2
  v_and_b32 v37, v40, v3
  v_and_b32 v38, v40, v4
  v_and_b32 v39, v40, v5
  s_nop 1
  v_mfma_f32_16x16x32_bf16 v[64:67], v[36:39], v[132:135], v[64:67]
  v_lshlrev_b32 v40, 16, v73
  v_lshlrev_b32 v41, 16, v89
  v_mul_f32 v40, s68, v40
  v_exp_f32 v40, -v40
  s_nop 0
  v_add_f32 v40, 1.0, v40
  v_rcp_f32 v40, v40
  s_nop 0
  v_cvt_pk_bf16_f32 v40, v40, v40
  v_and_b32 v40, 0xffff0000, v40
  v_mul_f32 v40, v40, v41
  v_cvt_pk_bf16_f32 v40, v40, v40
  v_and_b32 v36, v40, v2
  v_and_b32 v37, v40, v3
  v_and_b32 v38, v40, v4
  v_and_b32 v39, v40, v5
  s_nop 1
  v_mfma_f32_16x16x32_bf16 v[64:67], v[36:39], v[136:139], v[64:67]
  v_and_b32 v40, 0xffff0000, v73
  v_and_b32 v41, 0xffff0000, v89
  v_mul_f32 v40, s68, v40
  v_exp_f32 v40, -v40
  s_nop 0
  v_add_f32 v40, 1.0, v40
  v_rcp_f32 v40, v40
  s_nop 0
  v_cvt_pk_bf16_f32 v40, v40, v40
  v_and_b32 v40, 0xffff0000, v40
  v_mul_f32 v40, v40, v41
  v_cvt_pk_bf16_f32 v40, v40, v40
  v_and_b32 v36, v40, v2
  v_and_b32 v37, v40, v3
  v_and_b32 v38, v40, v4
  v_and_b32 v39, v40, v5
  s_nop 1
  v_mfma_f32_16x16x32_bf16 v[64:67], v[36:39], v[140:143], v[64:67]
  v_lshlrev_b32 v40, 16, v74
  v_lshlrev_b32 v41, 16, v90
  v_mul_f32 v40, s68, v40
  v_exp_f32 v40, -v40
  s_nop 0
  v_add_f32 v40, 1.0, v40
  v_rcp_f32 v40, v40
  s_nop 0
  v_cvt_pk_bf16_f32 v40, v40, v40
  v_and_b32 v40, 0xffff0000, v40
  v_mul_f32 v40, v40, v41
  v_cvt_pk_bf16_f32 v40, v40, v40
  v_and_b32 v36, v40, v2
  v_and_b32 v37, v40, v3
  v_and_b32 v38, v40, v4
  v_and_b32 v39, v40, v5
  s_nop 1
  v_mfma_f32_16x16x32_bf16 v[64:67], v[36:39], v[144:147], v[64:67]
  v_and_b32 v40, 0xffff0000, v74
  v_and_b32 v41, 0xffff0000, v90
  v_mul_f32 v40, s68, v40
  v_exp_f32 v40, -v40
  s_nop 0
  v_add_f32 v40, 1.0, v40
  v_rcp_f32 v40, v40
  s_nop 0
  v_cvt_pk_bf16_f32 v40, v40, v40
  v_and_b32 v40, 0xffff0000, v40
  v_mul_f32 v40, v40, v41
  v_cvt_pk_bf16_f32 v40, v40, v40
  v_and_b32 v36, v40, v2
  v_and_b32 v37, v40, v3
  v_and_b32 v38, v40, v4
  v_and_b32 v39, v40, v5
  s_nop 1
  v_mfma_f32_16x16x32_bf16 v[64:67], v[36:39], v[148:151], v[64:67]
  v_lshlrev_b32 v40, 16, v75
  v_lshlrev_b32 v41, 16, v91
  v_mul_f32 v40, s68, v40
  v_exp_f32 v40, -v40
  s_nop 0
  v_add_f32 v40, 1.0, v40
  v_rcp_f32 v40, v40
  s_nop 0
  v_cvt_pk_bf16_f32 v40, v40, v40
  v_and_b32 v40, 0xffff0000, v40
  v_mul_f32 v40, v40, v41
  v_cvt_pk_bf16_f32 v40, v40, v40
  v_and_b32 v36, v40, v2
  v_and_b32 v37, v40, v3
  v_and_b32 v38, v40, v4
  v_and_b32 v39, v40, v5
  s_nop 1
  v_mfma_f32_16x16x32_bf16 v[64:67], v[36:39], v[152:155], v[64:67]
  v_and_b32 v40, 0xffff0000, v75
  v_and_b32 v41, 0xffff0000, v91
  v_mul_f32 v40, s68, v40
  v_exp_f32 v40, -v40
  s_nop 0
  v_add_f32 v40, 1.0, v40
  v_rcp_f32 v40, v40
  s_nop 0
  v_cvt_pk_bf16_f32 v40, v40, v40
  v_and_b32 v40, 0xffff0000, v40
  v_mul_f32 v40, v40, v41
  v_cvt_pk_bf16_f32 v40, v40, v40
  v_and_b32 v36, v40, v2
  v_and_b32 v37, v40, v3
  v_and_b32 v38, v40, v4
  v_and_b32 v39, v40, v5
  s_nop 1
  v_mfma_f32_16x16x32_bf16 v[64:67], v[36:39], v[156:159], v[64:67]
  v_lshlrev_b32 v40, 16, v76
  v_lshlrev_b32 v41, 16, v92
  v_mul_f32 v40, s68, v40
  v_exp_f32 v40, -v40
  s_nop 0
  v_add_f32 v40, 1.0, v40
  v_rcp_f32 v40, v40
  s_nop 0
  v_cvt_pk_bf16_f32 v40, v40, v40
  v_and_b32 v40, 0xffff0000, v40
  v_mul_f32 v40, v40, v41
  v_cvt_pk_bf16_f32 v40, v40, v40
  v_and_b32 v36, v40, v2
  v_and_b32 v37, v40, v3
  v_and_b32 v38, v40, v4
  v_and_b32 v39, v40, v5
  s_nop 1
  v_mfma_f32_16x16x32_bf16 v[64:67], v[36:39], v[160:163], v[64:67]
  v_and_b32 v40, 0xffff0000, v76
  v_and_b32 v41, 0xffff0000, v92
  v_mul_f32 v40, s68, v40
  v_exp_f32 v40, -v40
  s_nop 0
  v_add_f32 v40, 1.0, v40
  v_rcp_f32 v40, v40
  s_nop 0
  v_cvt_pk_bf16_f32 v40, v40, v40
  v_and_b32 v40, 0xffff0000, v40
  v_mul_f32 v40, v40, v41
  v_cvt_pk_bf16_f32 v40, v40, v40
  v_and_b32 v36, v40, v2
  v_and_b32 v37, v40, v3
  v_and_b32 v38, v40, v4
  v_and_b32 v39, v40, v5
  s_nop 1
  v_mfma_f32_16x16x32_bf16 v[64:67], v[36:39], v[164:167], v[64:67]
  v_lshlrev_b32 v40, 16, v77
  v_lshlrev_b32 v41, 16, v93
  v_mul_f32 v40, s68, v40
  v_exp_f32 v40, -v40
  s_nop 0
  v_add_f32 v40, 1.0, v40
  v_rcp_f32 v40, v40
  s_nop 0
  v_cvt_pk_bf16_f32 v40, v40, v40
  v_and_b32 v40, 0xffff0000, v40
  v_mul_f32 v40, v40, v41
  v_cvt_pk_bf16_f32 v40, v40, v40
  v_and_b32 v36, v40, v2
  v_and_b32 v37, v40, v3
  v_and_b32 v38, v40, v4
  v_and_b32 v39, v40, v5
  s_nop 1
  v_mfma_f32_16x16x32_bf16 v[64:67], v[36:39], v[168:171], v[64:67]
  v_and_b32 v40, 0xffff0000, v77
  v_and_b32 v41, 0xffff0000, v93
  v_mul_f32 v40, s68, v40
  v_exp_f32 v40, -v40
  s_nop 0
  v_add_f32 v40, 1.0, v40
  v_rcp_f32 v40, v40
  s_nop 0
  v_cvt_pk_bf16_f32 v40, v40, v40
  v_and_b32 v40, 0xffff0000, v40
  v_mul_f32 v40, v40, v41
  v_cvt_pk_bf16_f32 v40, v40, v40
  v_and_b32 v36, v40, v2
  v_and_b32 v37, v40, v3
  v_and_b32 v38, v40, v4
  v_and_b32 v39, v40, v5
  s_nop 1
  v_mfma_f32_16x16x32_bf16 v[64:67], v[36:39], v[172:175], v[64:67]
  v_lshlrev_b32 v40, 16, v78
  v_lshlrev_b32 v41, 16, v94
  v_mul_f32 v40, s68, v40
  v_exp_f32 v40, -v40
  s_nop 0
  v_add_f32 v40, 1.0, v40
  v_rcp_f32 v40, v40
  s_nop 0
  v_cvt_pk_bf16_f32 v40, v40, v40
  v_and_b32 v40, 0xffff0000, v40
  v_mul_f32 v40, v40, v41
  v_cvt_pk_bf16_f32 v40, v40, v40
  v_and_b32 v36, v40, v2
  v_and_b32 v37, v40, v3
  v_and_b32 v38, v40, v4
  v_and_b32 v39, v40, v5
  s_nop 1
  v_mfma_f32_16x16x32_bf16 v[64:67], v[36:39], v[176:179], v[64:67]
  v_and_b32 v40, 0xffff0000, v78
  v_and_b32 v41, 0xffff0000, v94
  v_mul_f32 v40, s68, v40
  v_exp_f32 v40, -v40
  s_nop 0
  v_add_f32 v40, 1.0, v40
  v_rcp_f32 v40, v40
  s_nop 0
  v_cvt_pk_bf16_f32 v40, v40, v40
  v_and_b32 v40, 0xffff0000, v40
  v_mul_f32 v40, v40, v41
  v_cvt_pk_bf16_f32 v40, v40, v40
  v_and_b32 v36, v40, v2
  v_and_b32 v37, v40, v3
  v_and_b32 v38, v40, v4
  v_and_b32 v39, v40, v5
  s_nop 1
  v_mfma_f32_16x16x32_bf16 v[64:67], v[36:39], v[180:183], v[64:67]
  v_lshlrev_b32 v40, 16, v79
  v_lshlrev_b32 v41, 16, v95
  v_mul_f32 v40, s68, v40
  v_exp_f32 v40, -v40
  s_nop 0
  v_add_f32 v40, 1.0, v40
  v_rcp_f32 v40, v40
  s_nop 0
  v_cvt_pk_bf16_f32 v40, v40, v40
  v_and_b32 v40, 0xffff0000, v40
  v_mul_f32 v40, v40, v41
  v_cvt_pk_bf16_f32 v40, v40, v40
  v_and_b32 v36, v40, v2
  v_and_b32 v37, v40, v3
  v_and_b32 v38, v40, v4
  v_and_b32 v39, v40, v5
  s_nop 1
  v_mfma_f32_16x16x32_bf16 v[64:67], v[36:39], v[184:187], v[64:67]
  v_and_b32 v40, 0xffff0000, v79
  v_and_b32 v41, 0xffff0000, v95
  v_mul_f32 v40, s68, v40
  v_exp_f32 v40, -v40
  s_nop 0
  v_add_f32 v40, 1.0, v40
  v_rcp_f32 v40, v40
  s_nop 0
  v_cvt_pk_bf16_f32 v40, v40, v40
  v_and_b32 v40, 0xffff0000, v40
  v_mul_f32 v40, v40, v41
  v_cvt_pk_bf16_f32 v40, v40, v40
  v_and_b32 v36, v40, v2
  v_and_b32 v37, v40, v3
  v_and_b32 v38, v40, v4
  v_and_b32 v39, v40, v5
  s_nop 1
  v_mfma_f32_16x16x32_bf16 v[64:67], v[36:39], v[188:191], v[64:67]
  v_lshlrev_b32 v40, 16, v80
  v_lshlrev_b32 v41, 16, v96
  v_mul_f32 v40, s68, v40
  v_exp_f32 v40, -v40
  s_nop 0
  v_add_f32 v40, 1.0, v40
  v_rcp_f32 v40, v40
  s_nop 0
  v_cvt_pk_bf16_f32 v40, v40, v40
  v_and_b32 v40, 0xffff0000, v40
  v_mul_f32 v40, v40, v41
  v_cvt_pk_bf16_f32 v40, v40, v40
  v_and_b32 v36, v40, v2
  v_and_b32 v37, v40, v3
  v_and_b32 v38, v40, v4
  v_and_b32 v39, v40, v5
  s_nop 1
  v_mfma_f32_16x16x32_bf16 v[64:67], v[36:39], v[192:195], v[64:67]
  v_and_b32 v40, 0xffff0000, v80
  v_and_b32 v41, 0xffff0000, v96
  v_mul_f32 v40, s68, v40
  v_exp_f32 v40, -v40
  s_nop 0
  v_add_f32 v40, 1.0, v40
  v_rcp_f32 v40, v40
  s_nop 0
  v_cvt_pk_bf16_f32 v40, v40, v40
  v_and_b32 v40, 0xffff0000, v40
  v_mul_f32 v40, v40, v41
  v_cvt_pk_bf16_f32 v40, v40, v40
  v_and_b32 v36, v40, v2
  v_and_b32 v37, v40, v3
  v_and_b32 v38, v40, v4
  v_and_b32 v39, v40, v5
  s_nop 1
  v_mfma_f32_16x16x32_bf16 v[64:67], v[36:39], v[196:199], v[64:67]
  v_lshlrev_b32 v40, 16, v81
  v_lshlrev_b32 v41, 16, v97
  v_mul_f32 v40, s68, v40
  v_exp_f32 v40, -v40
  s_nop 0
  v_add_f32 v40, 1.0, v40
  v_rcp_f32 v40, v40
  s_nop 0
  v_cvt_pk_bf16_f32 v40, v40, v40
  v_and_b32 v40, 0xffff0000, v40
  v_mul_f32 v40, v40, v41
  v_cvt_pk_bf16_f32 v40, v40, v40
  v_and_b32 v36, v40, v2
  v_and_b32 v37, v40, v3
  v_and_b32 v38, v40, v4
  v_and_b32 v39, v40, v5
  s_nop 1
  v_mfma_f32_16x16x32_bf16 v[64:67], v[36:39], v[200:203], v[64:67]
  v_and_b32 v40, 0xffff0000, v81
  v_and_b32 v41, 0xffff0000, v97
  v_mul_f32 v40, s68, v40
  v_exp_f32 v40, -v40
  s_nop 0
  v_add_f32 v40, 1.0, v40
  v_rcp_f32 v40, v40
  s_nop 0
  v_cvt_pk_bf16_f32 v40, v40, v40
  v_and_b32 v40, 0xffff0000, v40
  v_mul_f32 v40, v40, v41
  v_cvt_pk_bf16_f32 v40, v40, v40
  v_and_b32 v36, v40, v2
  v_and_b32 v37, v40, v3
  v_and_b32 v38, v40, v4
  v_and_b32 v39, v40, v5
  s_nop 1
  v_mfma_f32_16x16x32_bf16 v[64:67], v[36:39], v[204:207], v[64:67]
  v_lshlrev_b32 v40, 16, v82
  v_lshlrev_b32 v41, 16, v98
  v_mul_f32 v40, s68, v40
  v_exp_f32 v40, -v40
  s_nop 0
  v_add_f32 v40, 1.0, v40
  v_rcp_f32 v40, v40
  s_nop 0
  v_cvt_pk_bf16_f32 v40, v40, v40
  v_and_b32 v40, 0xffff0000, v40
  v_mul_f32 v40, v40, v41
  v_cvt_pk_bf16_f32 v40, v40, v40
  v_and_b32 v36, v40, v2
  v_and_b32 v37, v40, v3
  v_and_b32 v38, v40, v4
  v_and_b32 v39, v40, v5
  s_nop 1
  v_mfma_f32_16x16x32_bf16 v[64:67], v[36:39], v[208:211], v[64:67]
  v_and_b32 v40, 0xffff0000, v82
  v_and_b32 v41, 0xffff0000, v98
  v_mul_f32 v40, s68, v40
  v_exp_f32 v40, -v40
  s_nop 0
  v_add_f32 v40, 1.0, v40
  v_rcp_f32 v40, v40
  s_nop 0
  v_cvt_pk_bf16_f32 v40, v40, v40
  v_and_b32 v40, 0xffff0000, v40
  v_mul_f32 v40, v40, v41
  v_cvt_pk_bf16_f32 v40, v40, v40
  v_and_b32 v36, v40, v2
  v_and_b32 v37, v40, v3
  v_and_b32 v38, v40, v4
  v_and_b32 v39, v40, v5
  s_nop 1
  v_mfma_f32_16x16x32_bf16 v[64:67], v[36:39], v[212:215], v[64:67]
  v_lshlrev_b32 v40, 16, v83
  v_lshlrev_b32 v41, 16, v99
  v_mul_f32 v40, s68, v40
  v_exp_f32 v40, -v40
  s_nop 0
  v_add_f32 v40, 1.0, v40
  v_rcp_f32 v40, v40
  s_nop 0
  v_cvt_pk_bf16_f32 v40, v40, v40
  v_and_b32 v40, 0xffff0000, v40
  v_mul_f32 v40, v40, v41
  v_cvt_pk_bf16_f32 v40, v40, v40
  v_and_b32 v36, v40, v2
  v_and_b32 v37, v40, v3
  v_and_b32 v38, v40, v4
  v_and_b32 v39, v40, v5
  s_nop 1
  v_mfma_f32_16x16x32_bf16 v[64:67], v[36:39], v[216:219], v[64:67]
  v_and_b32 v40, 0xffff0000, v83
  v_and_b32 v41, 0xffff0000, v99
  v_mul_f32 v40, s68, v40
  v_exp_f32 v40, -v40
  s_nop 0
  v_add_f32 v40, 1.0, v40
  v_rcp_f32 v40, v40
  s_nop 0
  v_cvt_pk_bf16_f32 v40, v40, v40
  v_and_b32 v40, 0xffff0000, v40
  v_mul_f32 v40, v40, v41
  v_cvt_pk_bf16_f32 v40, v40, v40
  v_and_b32 v36, v40, v2
  v_and_b32 v37, v40, v3
  v_and_b32 v38, v40, v4
  v_and_b32 v39, v40, v5
  s_nop 1
  v_mfma_f32_16x16x32_bf16 v[64:67], v[36:39], v[220:223], v[64:67]
  v_lshlrev_b32 v40, 16, v84
  v_lshlrev_b32 v41, 16, v100
  v_mul_f32 v40, s68, v40
  v_exp_f32 v40, -v40
  s_nop 0
  v_add_f32 v40, 1.0, v40
  v_rcp_f32 v40, v40
  s_nop 0
  v_cvt_pk_bf16_f32 v40, v40, v40
  v_and_b32 v40, 0xffff0000, v40
  v_mul_f32 v40, v40, v41
  v_cvt_pk_bf16_f32 v40, v40, v40
  v_and_b32 v36, v40, v2
  v_and_b32 v37, v40, v3
  v_and_b32 v38, v40, v4
  v_and_b32 v39, v40, v5
  s_nop 1
  v_mfma_f32_16x16x32_bf16 v[64:67], v[36:39], v[224:227], v[64:67]
  v_and_b32 v40, 0xffff0000, v84
  v_and_b32 v41, 0xffff0000, v100
  v_mul_f32 v40, s68, v40
  v_exp_f32 v40, -v40
  s_nop 0
  v_add_f32 v40, 1.0, v40
  v_rcp_f32 v40, v40
  s_nop 0
  v_cvt_pk_bf16_f32 v40, v40, v40
  v_and_b32 v40, 0xffff0000, v40
  v_mul_f32 v40, v40, v41
  v_cvt_pk_bf16_f32 v40, v40, v40
  v_and_b32 v36, v40, v2
  v_and_b32 v37, v40, v3
  v_and_b32 v38, v40, v4
  v_and_b32 v39, v40, v5
  s_nop 1
  v_mfma_f32_16x16x32_bf16 v[64:67], v[36:39], v[228:231], v[64:67]
  v_lshlrev_b32 v40, 16, v85
  v_lshlrev_b32 v41, 16, v101
  v_mul_f32 v40, s68, v40
  v_exp_f32 v40, -v40
  s_nop 0
  v_add_f32 v40, 1.0, v40
  v_rcp_f32 v40, v40
  s_nop 0
  v_cvt_pk_bf16_f32 v40, v40, v40
  v_and_b32 v40, 0xffff0000, v40
  v_mul_f32 v40, v40, v41
  v_cvt_pk_bf16_f32 v40, v40, v40
  v_and_b32 v36, v40, v2
  v_and_b32 v37, v40, v3
  v_and_b32 v38, v40, v4
  v_and_b32 v39, v40, v5
  s_nop 1
  v_mfma_f32_16x16x32_bf16 v[64:67], v[36:39], v[232:235], v[64:67]
  v_and_b32 v40, 0xffff0000, v85
  v_and_b32 v41, 0xffff0000, v101
  v_mul_f32 v40, s68, v40
  v_exp_f32 v40, -v40
  s_nop 0
  v_add_f32 v40, 1.0, v40
  v_rcp_f32 v40, v40
  s_nop 0
  v_cvt_pk_bf16_f32 v40, v40, v40
  v_and_b32 v40, 0xffff0000, v40
  v_mul_f32 v40, v40, v41
  v_cvt_pk_bf16_f32 v40, v40, v40
  v_and_b32 v36, v40, v2
  v_and_b32 v37, v40, v3
  v_and_b32 v38, v40, v4
  v_and_b32 v39, v40, v5
  s_nop 1
  v_mfma_f32_16x16x32_bf16 v[64:67], v[36:39], v[236:239], v[64:67]
  v_lshlrev_b32 v40, 16, v86
  v_lshlrev_b32 v41, 16, v102
  v_mul_f32 v40, s68, v40
  v_exp_f32 v40, -v40
  s_nop 0
  v_add_f32 v40, 1.0, v40
  v_rcp_f32 v40, v40
  s_nop 0
  v_cvt_pk_bf16_f32 v40, v40, v40
  v_and_b32 v40, 0xffff0000, v40
  v_mul_f32 v40, v40, v41
  v_cvt_pk_bf16_f32 v40, v40, v40
  v_and_b32 v36, v40, v2
  v_and_b32 v37, v40, v3
  v_and_b32 v38, v40, v4
  v_and_b32 v39, v40, v5
  s_nop 1
  v_mfma_f32_16x16x32_bf16 v[64:67], v[36:39], v[240:243], v[64:67]
  v_and_b32 v40, 0xffff0000, v86
  v_and_b32 v41, 0xffff0000, v102
  v_mul_f32 v40, s68, v40
  v_exp_f32 v40, -v40
  s_nop 0
  v_add_f32 v40, 1.0, v40
  v_rcp_f32 v40, v40
  s_nop 0
  v_cvt_pk_bf16_f32 v40, v40, v40
  v_and_b32 v40, 0xffff0000, v40
  v_mul_f32 v40, v40, v41
  v_cvt_pk_bf16_f32 v40, v40, v40
  v_and_b32 v36, v40, v2
  v_and_b32 v37, v40, v3
  v_and_b32 v38, v40, v4
  v_and_b32 v39, v40, v5
  s_nop 1
  v_mfma_f32_16x16x32_bf16 v[64:67], v[36:39], v[244:247], v[64:67]
  v_lshlrev_b32 v40, 16, v87
  v_lshlrev_b32 v41, 16, v103
  v_mul_f32 v40, s68, v40
  v_exp_f32 v40, -v40
  s_nop 0
  v_add_f32 v40, 1.0, v40
  v_rcp_f32 v40, v40
  s_nop 0
  v_cvt_pk_bf16_f32 v40, v40, v40
  v_and_b32 v40, 0xffff0000, v40
  v_mul_f32 v40, v40, v41
  v_cvt_pk_bf16_f32 v40, v40, v40
  v_and_b32 v36, v40, v2
  v_and_b32 v37, v40, v3
  v_and_b32 v38, v40, v4
  v_and_b32 v39, v40, v5
  s_nop 1
  v_mfma_f32_16x16x32_bf16 v[64:67], v[36:39], v[248:251], v[64:67]
  v_and_b32 v40, 0xffff0000, v87
  v_and_b32 v41, 0xffff0000, v103
  v_mul_f32 v40, s68, v40
  v_exp_f32 v40, -v40
  s_nop 0
  v_add_f32 v40, 1.0, v40
  v_rcp_f32 v40, v40
  s_nop 0
  v_cvt_pk_bf16_f32 v40, v40, v40
  v_and_b32 v40, 0xffff0000, v40
  v_mul_f32 v40, v40, v41
  v_cvt_pk_bf16_f32 v40, v40, v40
  v_and_b32 v36, v40, v2
  v_and_b32 v37, v40, v3
  v_and_b32 v38, v40, v4
  v_and_b32 v39, v40, v5
  s_nop 1
  v_mfma_f32_16x16x32_bf16 v[64:67], v[36:39], v[252:255], v[64:67]
  s_nop 7
  buffer_store_dwordx4 v[64:67], v10, s[52:55], s75 offen sc1
L_b_rpt:
  s_lshl_b32 s10, s7, 7
  s_add_u32 s10, s10, 589824
  s_waitcnt vmcnt(0)
  v_mov_b32 v13, 0
  v_mov_b32 v14, 65543
  s_mov_b64 exec, 1
  buffer_store_dword v14, v13, s[52:55], s10 offen offset:0 sc1
  s_mov_b64 exec, -1
  s_branch L_final2
L_coord:
  v_mov_b32 v13, 0
  buffer_load_dword v13, v13, s[56:59], 0 offen offset:128 sc1
  s_waitcnt vmcnt(0)
  v_cmp_eq_u32 vcc, 0, v13
  s_cbranch_vccz L_fin
  v_lshlrev_b32 v6, 7, v0
  v_mov_b32 v112, 0
  s_mov_b32 s74, 589824
  v_mov_b32 v113, 0
  s_mov_b32 s75, 598016
  v_mov_b32 v114, 0
  s_mov_b32 s76, 606208
  v_mov_b32 v115, 0
  s_mov_b32 s77, 614400
  v_mov_b32 v12, 0
  s_mov_b32 s15, 0
L_c1e:
  ds_read_b32 v13, v12 offset:3908
  s_waitcnt lgkmcnt(0)
  v_cmp_gt_u32 vcc, 1, v13
  s_cbranch_vccz L_c1e_ok
  s_sleep 32
  s_add_u32 s15, s15, 1
  s_cmp_lt_u32 s15, 67669
  s_cbranch_scc1 L_c1e
L_c1e_ok:
  s_mov_b32 s15, 0
L_co0:
  s_sleep 127
  v_cmp_gt_u32 vcc, 3, v112
  s_cbranch_vccz L_co0_s0
  s_mov_b64 exec, vcc
  buffer_load_dword v112, v6, s[52:55], s74 offen sc1
  s_waitcnt vmcnt(0)
  s_mov_b64 exec, -1
L_co0_s0:
  v_cmp_gt_u32 vcc, 3, v113
  s_cbranch_vccz L_co0_s1
  s_mov_b64 exec, vcc
  buffer_load_dword v113, v6, s[52:55], s75 offen sc1
  s_waitcnt vmcnt(0)
  s_mov_b64 exec, -1
L_co0_s1:
  v_cmp_gt_u32 vcc, 3, v114
  s_cbranch_vccz L_co0_s2
  s_mov_b64 exec, vcc
  buffer_load_dword v114, v6, s[52:55], s76 offen sc1
  s_waitcnt vmcnt(0)
  s_mov_b64 exec, -1
L_co0_s2:
  v_cmp_gt_u32 vcc, 3, v115
  s_cbranch_vccz L_co0_s3
  s_mov_b64 exec, vcc
  buffer_load_dword v115, v6, s[52:55], s77 offen sc1
  s_waitcnt vmcnt(0)
  s_mov_b64 exec, -1
L_co0_s3:
  s_waitcnt vmcnt(0)
  v_min_u32 v7, v112, v113
  v_min3_u32 v7, v114, v115, v7
  v_cmp_gt_u32 vcc, 3, v7
  s_cbranch_vccz L_co0_ok
  s_add_u32 s15, s15, 1
  s_cmp_lt_u32 s15, 16689
  s_cbranch_scc1 L_co0
L_co0_ok:
  v_max_u32 v8, v112, v113
  v_max3_u32 v8, v114, v115, v8
  s_nop 1
  v_min_u32_dpp v7, v7, v7 quad_perm:[1,0,3,2] row_mask:0xf bank_mask:0xf
  s_nop 1
  v_min_u32_dpp v7, v7, v7 quad_perm:[2,3,0,1] row_mask:0xf bank_mask:0xf
  s_nop 1
  v_min_u32_dpp v7, v7, v7 row_half_mirror row_mask:0xf bank_mask:0xf
  s_nop 1
  v_max_u32_dpp v8, v8, v8 quad_perm:[1,0,3,2] row_mask:0xf bank_mask:0xf
  s_nop 1
  v_max_u32_dpp v8, v8, v8 quad_perm:[2,3,0,1] row_mask:0xf bank_mask:0xf
  s_nop 1
  v_max_u32_dpp v8, v8, v8 row_half_mirror row_mask:0xf bank_mask:0xf
  s_nop 1
  v_cmp_ne_u32 vcc, v7, v8
  s_nop 3
  s_and_b32 s10, vcc_lo, 0x01010101
  s_and_b32 s11, vcc_hi, 0x01010101
  s_lshl_b32 s11, s11, 1
  s_or_b32 s10, s10, s11
  s_or_b32 s10, s10, 0x80
  v_mov_b32 v13, 0
  v_mov_b32 v14, s10
  s_mov_b64 exec, 1
  buffer_store_dword v14, v13, s[56:59], 0 offen offset:128 sc1
  s_mov_b64 exec, -1
  s_branch L_fin
L_coord2:
  v_mov_b32 v13, 0
  buffer_load_dword v13, v13, s[56:59], 0 offen offset:192 sc1
  s_waitcnt vmcnt(0)
  v_cmp_eq_u32 vcc, 0, v13
  s_cbranch_vccz L_fin
  v_lshrrev_b32 v6, 1, v0
  v_and_b32 v7, 1, v0
  v_lshl_add_u32 v6, v6, 3, v7
  v_lshlrev_b32 v6, 7, v6
  s_mov_b32 s74, 590592
  v_mov_b32 v12, 0
  s_mov_b32 s15, 0
L_c2e:
  ds_read_b32 v13, v12 offset:3908
  s_waitcnt lgkmcnt(0)
  v_cmp_gt_u32 vcc, 5, v13
  s_cbranch_vccz L_c2e_ok
  s_sleep 32
  s_add_u32 s15, s15, 1
  s_cmp_lt_u32 s15, 67669
  s_cbranch_scc1 L_c2e
L_c2e_ok:
  s_mov_b32 s15, 0
L_c2g:
  v_mov_b32 v13, 0
  buffer_load_dword v13, v13, s[56:59], 0 offen offset:128 sc1
  s_waitcnt vmcnt(0)
  v_cmp_eq_u32 vcc, 0, v13
  s_cbranch_vccz L_c2g_ok
  s_sleep 100
  s_add_u32 s15, s15, 1
  s_cmp_lt_u32 s15, 20869
  s_cbranch_scc1 L_c2g
L_c2g_ok:
  s_mov_b32 s15, 0
L_co1:
  s_sleep 127
  buffer_load_dword v112, v6, s[52:55], s74 offen sc1
  s_waitcnt vmcnt(0)
  v_cmp_gt_u32 vcc, 0x10000, v112
  s_cbranch_vccz L_co1_ok
  s_mov_b64 exec, vcc
  s_add_u32 s15, s15, 1
  s_cmp_lt_u32 s15, 16689
  s_cbranch_scc1 L_co1
L_co1_ok:
  s_mov_b64 exec, -1
  v_mov_b32 v13, 0
  v_mov_b32 v14, 1
  s_mov_b64 exec, 1
  buffer_store_dword v14, v13, s[56:59], 0 offen offset:192 sc1
  s_mov_b64 exec, -1
  s_branch L_fin
L_lagc:
  v_mov_b32 v12, 0
  s_mov_b32 s15, 0
L_lge:
  ds_read_b32 v13, v12 offset:3908
  s_waitcnt lgkmcnt(0)
  v_cmp_gt_u32 vcc, 2, v13
  s_cbranch_vccz L_lge_ok
  s_sleep 32
  s_add_u32 s15, s15, 1
  s_cmp_lt_u32 s15, 67669
  s_cbranch_scc1 L_lge
L_lge_ok:
  v_and_b32 v6, 15, v0
  v_lshlrev_b32 v6, 10, v6
  s_mov_b32 s74, 589828
  v_mov_b32 v7, 0
  s_mov_b32 s15, 0
  s_mov_b32 s75, 0
  s_mov_b32 s76, 0
  s_mov_b32 s77, 0
  s_mov_b32 s78, 0
L_lg:
  s_sleep 127
  s_sleep 93
  buffer_load_dwordx2 v[112:113], v6, s[52:55], s74 offen sc1
  ds_read_b32 v8, v7 offset:3908
  s_waitcnt vmcnt(0) lgkmcnt(0)
  v_readfirstlane_b32 s10, v112
  v_readfirstlane_b32 s11, v8
  v_cmp_eq_u32 vcc, 0, v112
  s_cbranch_vccnz L_lg_skip
  v_subrev_u32 v112, s10, v112
  v_subrev_u32 v113, s10, v113
  s_nop 1
  v_add_u32_dpp v112, v112, v112 quad_perm:[1,0,3,2] row_mask:0xf bank_mask:0xf
  v_add_u32_dpp v113, v113, v113 quad_perm:[1,0,3,2] row_mask:0xf bank_mask:0xf
  s_nop 0
  v_add_u32_dpp v112, v112, v112 quad_perm:[2,3,0,1] row_mask:0xf bank_mask:0xf
  v_add_u32_dpp v113, v113, v113 quad_perm:[2,3,0,1] row_mask:0xf bank_mask:0xf
  s_nop 0
  v_add_u32_dpp v112, v112, v112 row_half_mirror row_mask:0xf bank_mask:0xf
  v_add_u32_dpp v113, v113, v113 row_half_mirror row_mask:0xf bank_mask:0xf
  s_nop 0
  v_add_u32_dpp v112, v112, v112 row_mirror row_mask:0xf bank_mask:0xf
  v_add_u32_dpp v113, v113, v113 row_mirror row_mask:0xf bank_mask:0xf
  s_nop 0
  v_mov_b32 v9, v112
  s_nop 1
  v_permlane16_swap_b32 v112, v9
  s_nop 1
  v_add_u32 v112, v112, v9
  v_mov_b32 v9, v112
  s_nop 1
  v_permlane32_swap_b32 v112, v9
  s_nop 1
  v_add_u32 v112, v112, v9
  v_ashrrev_i32 v112, 6, v112
  v_add_u32 v112, s10, v112
  v_mov_b32 v9, v113
  s_nop 1
  v_permlane16_swap_b32 v113, v9
  s_nop 1
  v_add_u32 v113, v113, v9
  v_mov_b32 v9, v113
  s_nop 1
  v_permlane32_swap_b32 v113, v9
  s_nop 1
  v_add_u32 v113, v113, v9
  v_ashrrev_i32 v113, 6, v113
  v_add_u32 v113, s10, v113
  v_or_b32 v112, 1, v112
  s_cmp_eq_u32 s77, 0
  s_cselect_b32 s77, s75, s77
  s_cselect_b32 s78, s76, s78
  v_subrev_u32 v9, s77, v112
  v_subrev_u32 v10, s78, v113
  v_max_i32 v10, 100, v10
  v_cvt_f32_i32 v9, v9
  v_cvt_f32_i32 v10, v10
  v_rcp_f32 v10, v10
  v_mul_f32 v9, 0x43a00000, v9
  v_mul_f32 v9, v9, v10
  v_cvt_i32_f32 v9, v9
  v_min_i32 v9, 40, v9
  v_max_i32 v114, 0, v9
  s_cmp_eq_u32 s77, 0
  s_cbranch_scc0 L_lg_hs
  v_mov_b32 v114, 0
L_lg_hs:
  s_mov_b32 s77, s75
  s_mov_b32 s78, s76
  v_readfirstlane_b32 s75, v112
  v_readfirstlane_b32 s76, v113
  s_mov_b64 exec, 1
  buffer_store_dwordx3 v[112:114], v7, s[56:59], 0 offen offset:64 sc1
  s_mov_b64 exec, -1
L_lg_skip:
  s_cmp_ge_u32 s11, 11
  s_cbranch_scc1 L_fin
  s_add_u32 s15, s15, 1
  s_cmp_lt_u32 s15, 9876
  s_cbranch_scc1 L_lg
  s_branch L_fin
L_x3:
  v_lshlrev_b32 v10, 4, v0
  s_mul_i32 s74, s3, 3072
  s_add_u32 s74, s74, 655360
  v_mov_b32 v12, 0
  s_cmp_eq_u32 s91, 0
  s_cbranch_scc0 L_x3_duty
  s_sleep 127
  s_sleep 73
L_x3_duty:
  s_mov_b32 s15, 0
L_x3c:
  ds_read_b32 v13, v12 offset:3876
  s_waitcnt lgkmcnt(0)
  v_cmp_gt_u32 vcc, 1, v13
  s_cbranch_vccz L_x3c_ok
  s_sleep 4
  s_add_u32 s15, s15, 1
  s_cmp_lt_u32 s15, 428571
  s_cbranch_scc1 L_x3c
L_x3c_ok:
  s_lshl_b32 s10, s3, 2
  s_mov_b32 s15, 0
L_x3d:
  v_mov_b32 v13, 0
  buffer_load_dword v13, v13, s[56:59], s10 offen offset:16 sc1
  s_waitcnt vmcnt(0)
  v_cmp_eq_u32 vcc, 0, v13
  s_cbranch_vccz L_x3d_ok
  s_sleep 16
  s_add_u32 s15, s15, 1
  s_cmp_lt_u32 s15, 94488
  s_cbranch_scc1 L_x3d
L_x3d_ok:
  s_sleep 30
  s_mov_b32 s15, 0
L_q2:
  buffer_load_dwordx4 v[128:131], v10, s[52:55], s74 offen offset:0 sc1
  buffer_load_dwordx4 v[132:135], v10, s[52:55], s74 offen offset:1024 sc1
  buffer_load_dwordx4 v[136:139], v10, s[52:55], s74 offen offset:2048 sc1
  s_waitcnt vmcnt(0)
  v_max_u32 v13, v128, v129
  v_max3_u32 v13, v130, v131, v13
  v_max3_u32 v13, v132, v133, v13
  v_max3_u32 v13, v134, v135, v13
  v_max3_u32 v13, v136, v137, v13
  v_max3_u32 v13, v138, v139, v13
  v_cmp_eq_u32 vcc, -1, v13
  s_cbranch_vccz L_q2_ok
  s_mov_b64 exec, vcc
  s_sleep 20
  s_add_u32 s15, s15, 1
  s_cmp_lt_u32 s15, 80898
  s_cbranch_scc1 L_q2
L_q2_ok:
  s_mov_b64 exec, -1
  ds_write_b128 v10, v[128:131] offset:0
  ds_write_b128 v10, v[132:135] offset:1024
  ds_write_b128 v10, v[136:139] offset:2048
  v_mov_b32 v14, 1
  ds_write_b32 v12, v14 offset:3844
  s_mov_b32 s40, s24
  s_mov_b32 s41, s25
  s_mov_b32 s42, 0
  s_mov_b32 s43, 0x20000
  v_mov_b32 v8, 0
  v_mov_b32 v9, 0
  v_mov_b32 v10, 0
  v_mov_b32 v126, 0
  v_mov_b32 v127, 0
  s_cmp_lt_u32 s6, 5
  s_cbranch_scc1 L_oproj2
  s_branch L_x3_ctl
L_x2:
  v_mov_b32 v112, -1
  v_mov_b32 v113, -1
  v_mov_b32 v114, -1
  v_mov_b32 v115, -1
  s_mov_b32 s40, s24
  s_mov_b32 s41, s25
  s_mov_b32 s42, 0
  s_mov_b32 s43, 0x20000
  v_mov_b32 v8, 0
  v_mov_b32 v9, 0
  v_mov_b32 v10, 0
  v_mov_b32 v126, 0
  v_mov_b32 v127, 0
  v_lshlrev_b32 v11, 4, v0
  s_mul_i32 s10, s5, 5120
  s_lshl_b32 s11, s6, 10
  s_add_u32 s10, s10, s11
  s_add_u32 s10, s10, 720896
  s_cmp_lt_u32 s6, 5
  s_cselect_b32 s10, s10, 4194304
  buffer_store_dwordx4 v[112:115], v11, s[52:55], s10 offen sc1
  s_lshl_b32 s10, s3, 7
  s_add_u32 s10, s10, 688128
  s_cmp_eq_u32 s8, 8
  s_cselect_b32 s10, s10, 4194304
  s_mov_b32 exec_lo, 0xff
  s_mov_b32 exec_hi, 0x0
  buffer_store_dwordx4 v[112:115], v11, s[52:55], s10 offen sc1
  s_mov_b64 exec, -1
  s_lshl_b32 s81, s3, 5
  s_add_u32 s81, s81, s8
  s_lshl_b32 s81, s81, 7
  s_add_u32 s81, s81, 622592
  s_mov_b64 exec, 15
  buffer_store_dwordx4 v[112:115], v11, s[52:55], s81 offen sc1
  v_mov_b32 v14, 1
  s_waitcnt vmcnt(0)
  s_mov_b64 exec, 1
  ds_add_u32 v8, v14 offset:3848
  s_mov_b64 exec, -1
  s_cmp_lt_u32 s6, 5
  s_cbranch_scc0 L_x2_ml
L_oproj:
L_oproj2:
  v_and_b32 v6, 15, v0
  v_lshrrev_b32 v7, 4, v0
  s_sub_u32 s12, s4, 4
  v_mul_u32_u24 v8, 15360, v7
  v_lshl_add_u32 v8, v6, 4, v8
  s_mul_i32 s10, s5, 245760
  s_mul_i32 s11, s12, 61440
  s_add_u32 s10, s10, s11
  s_lshl_b32 s11, s6, 8
  v_add_u32 v8, s11, v8
  s_add_u32 s40, s24, s10
  s_addc_u32 s41, s25, 0
  s_mov_b32 s42, 61440
  s_mov_b32 s43, 0x20000
  s_movk_i32 s75, 5120
  s_movk_i32 s76, 10240
  s_mov_b32 s93, 0
  v_mov_b32 v126, v8
  s_cmp_lt_u32 s8, 32
  s_cbranch_scc1 L_wo_skip
  s_waitcnt vmcnt(0)
  buffer_load_dwordx4 v[128:131], v126, s[40:43], 0 offen offset:0 nt
  s_waitcnt vmcnt(0)
  buffer_load_dwordx4 v[132:135], v126, s[40:43], 0 offen offset:1280 nt
  s_waitcnt vmcnt(0)
  buffer_load_dwordx4 v[136:139], v126, s[40:43], 0 offen offset:2560 nt
  s_waitcnt vmcnt(0)
  buffer_load_dwordx4 v[140:143], v126, s[40:43], 0 offen offset:3840 nt
  s_waitcnt vmcnt(0)
  buffer_load_dwordx4 v[144:147], v126, s[40:43], s75 offen offset:0 nt
  s_waitcnt vmcnt(0)
  buffer_load_dwordx4 v[148:151], v126, s[40:43], s75 offen offset:1280 nt
  s_waitcnt vmcnt(0)
  buffer_load_dwordx4 v[152:155], v126, s[40:43], s75 offen offset:2560 nt
  s_waitcnt vmcnt(0)
  buffer_load_dwordx4 v[156:159], v126, s[40:43], s75 offen offset:3840 nt
  s_waitcnt vmcnt(0)
  buffer_load_dwordx4 v[160:163], v126, s[40:43], s76 offen offset:0 nt
  s_waitcnt vmcnt(0)
  buffer_load_dwordx4 v[164:167], v126, s[40:43], s76 offen offset:1280 nt
  s_waitcnt vmcnt(0)
  buffer_load_dwordx4 v[168:171], v126, s[40:43], s76 offen offset:2560 nt
  s_waitcnt vmcnt(0)
  buffer_load_dwordx4 v[172:175], v126, s[40:43], s76 offen offset:3840 nt
L_wo_skip:
  v_lshrrev_b32 v9, 2, v6
  v_mul_u32_u24 v9, 3, v9
  v_and_b32 v8, 3, v6
  v_min_u32 v13, 2, v8
  v_add_u32 v9, v9, v13
  v_mul_u32_u24 v13, 768, v7
  v_lshl_add_u32 v9, v9, 4, v13
  s_lshl_b32 s10, s3, 3
  s_lshr_b32 s11, s8, 3
  s_add_u32 s13, s10, s11
  s_mul_i32 s10, s13, 12288
  s_mul_i32 s11, s12, 192
  s_add_u32 s10, s10, s11
  s_add_u32 s10, s10, 1310720
  v_add_u32 v9, s10, v9
  s_movk_i32 s78, 6144
  v_cmp_lt_u32 vcc, 7, v6
  v_mov_b32 v13, 0x3f803f80
  v_or_b32 v104, v2, v4
  v_or_b32 v105, v3, v5
  v_and_b32 v104, v104, v13
  v_and_b32 v105, v105, v13
  v_cndmask_b32 v108, v104, 0, vcc
  v_cndmask_b32 v109, v105, 0, vcc
  v_cndmask_b32 v110, v104, 0, vcc
  v_cndmask_b32 v111, v105, 0, vcc
  v_cndmask_b32 v107, 0, v105, vcc
  v_cndmask_b32 v106, 0, v104, vcc
  v_cndmask_b32 v105, 0, v105, vcc
  v_cndmask_b32 v104, 0, v104, vcc
  s_lshl_b32 s10, s12, 10
  v_lshlrev_b32 v10, 4, v0
  v_add_u32 v10, s10, v10
  v_and_b32 v127, 15, v0
  v_lshlrev_b32 v127, 5, v127
  v_and_b32 v13, 16, v0
  v_add_u32 v127, v127, v13
  v_lshrrev_b32 v13, 5, v0
  v_lshl_add_u32 v127, v13, 9, v127
  s_mul_i32 s77, s5, 5120
  s_lshl_b32 s11, s6, 10
  s_add_u32 s77, s77, s11
  s_add_u32 s77, s77, 720896
  s_cmp_eq_u32 s4, 7
  s_cbranch_scc1 L_x3_ctl
  s_cmp_eq_u32 s4, 6
  s_cbranch_scc0 L_b0wait
L_x2_ml:
  v_mov_b32 v12, 0
  s_mov_b32 s15, 0
L_x2d:
  ds_read_b32 v13, v12 offset:3908
  s_waitcnt lgkmcnt(0)
  v_cmp_gt_u32 vcc, 6, v13
  s_cbranch_vccz L_x2d_ok
  s_sleep 32
  s_add_u32 s15, s15, 1
  s_cmp_lt_u32 s15, 67669
  s_cbranch_scc1 L_x2d
L_x2d_ok:
  s_mov_b32 s15, 0
L_x2g:
  v_mov_b32 v14, 0
  buffer_load_dword v14, v14, s[56:59], 0 offen offset:128 sc1
  s_waitcnt vmcnt(0)
  v_cmp_eq_u32 vcc, 0, v14
  s_cbranch_vccz L_x2g_ok
  s_sleep 64
  s_add_u32 s15, s15, 1
  s_cmp_lt_u32 s15, 31331
  s_cbranch_scc1 L_x2g
L_x2g_ok:
  v_readfirstlane_b32 s69, v14
  s_and_b32 s10, s3, 3
  s_lshl_b32 s10, s10, 3
  s_lshr_b32 s11, s3, 2
  s_add_u32 s10, s10, s11
  s_lshr_b32 s69, s69, s10
  s_and_b32 s69, s69, 1
  v_lshlrev_b32 v11, 4, v0
  v_mov_b32 v112, -1
  v_mov_b32 v113, -1
  v_mov_b32 v114, -1
  v_mov_b32 v115, -1
  s_mul_i32 s80, s3, 98304
  s_add_u32 s80, s80, 1310720
  s_mul_i32 s12, s8, 3072
  s_add_u32 s12, s12, s80
  s_cmp_eq_u32 s69, 0
  s_cbranch_scc0 L_lc_far
  buffer_store_dwordx4 v[112:115], v11, s[52:55], s12 offen offset:0
  buffer_store_dwordx4 v[112:115], v11, s[52:55], s12 offen offset:1024
  buffer_store_dwordx4 v[112:115], v11, s[52:55], s12 offen offset:2048
  s_branch L_lc_done
L_lc_far:
  buffer_store_dwordx4 v[112:115], v11, s[52:55], s12 offen offset:0 sc1
  buffer_store_dwordx4 v[112:115], v11, s[52:55], s12 offen offset:1024 sc1
  buffer_store_dwordx4 v[112:115], v11, s[52:55], s12 offen offset:2048 sc1
L_lc_done:
  v_and_b32 v12, 31, v0
  v_lshlrev_b32 v13, 3, v12
  s_mov_b32 s15, 0
L_lml:
  s_sleep 32
  ds_read_b64 v[112:113], v13 offset:3584
  s_waitcnt lgkmcnt(0)
  v_max_u32 v14, v112, v113
  v_cmp_eq_u32 vcc, -1, v14
  s_cbranch_vccz L_lml_ok
  s_add_u32 s15, s15, 1
  s_cmp_lt_u32 s15, 67669
  s_cbranch_scc1 L_lml
L_lml_ok:
  v_mov_b32 v114, v112
  s_nop 1
  v_max_f32_dpp v114, v114, v114 quad_perm:[1,0,3,2] row_mask:0xf bank_mask:0xf
  s_nop 1
  v_max_f32_dpp v114, v114, v114 quad_perm:[2,3,0,1] row_mask:0xf bank_mask:0xf
  s_nop 1
  v_sub_f32 v115, v112, v114
  v_mul_f32 v115, s68, v115
  v_exp_f32 v115, v115
  s_nop 0
  v_mul_f32 v115, v115, v113
  s_nop 1
  v_add_f32_dpp v115, v115, v115 quad_perm:[1,0,3,2] row_mask:0xf bank_mask:0xf
  s_nop 1
  v_add_f32_dpp v115, v115, v115 quad_perm:[2,3,0,1] row_mask:0xf bank_mask:0xf
  s_nop 1
  v_min_u32 v114, -2, v114
  v_min_u32 v115, -2, v115
  v_lshrrev_b32 v13, 2, v12
  v_lshlrev_b32 v13, 3, v13
  s_waitcnt vmcnt(0)
  s_mov_b32 exec_lo, 0x11111111
  s_mov_b32 exec_hi, 0x0
  s_cmp_eq_u32 s69, 0
  s_cbranch_scc0 L_mls_far
  buffer_store_dwordx2 v[114:115], v13, s[52:55], s81 offen
  s_branch L_mls_done
L_mls_far:
  buffer_store_dwordx2 v[114:115], v13, s[52:55], s81 offen sc1
L_mls_done:
  s_mov_b64 exec, -1
  s_lshl_b32 s10, s3, 7
  s_add_u32 s10, s10, 688128
  v_mov_b32 v117, 0
  s_mov_b32 s15, 0
L_x2e:
  ds_read_b32 v14, v117 offset:3908
  s_waitcnt lgkmcnt(0)
  v_cmp_gt_u32 vcc, 9, v14
  s_cbranch_vccz L_x2e_ok
  s_sleep 16
  s_add_u32 s15, s15, 1
  s_cmp_lt_u32 s15, 130434
  s_cbranch_scc1 L_x2e
L_x2e_ok:
  s_mov_b32 s15, 0
L_mg:
  buffer_load_dwordx2 v[114:115], v13, s[52:55], s10 offen sc1
  s_waitcnt vmcnt(0)
  v_max_u32 v14, v114, v115
  v_cmp_eq_u32 vcc, -1, v14
  s_cbranch_vccz L_mg_ok
  s_mov_b64 exec, vcc
  s_sleep 48
  s_add_u32 s15, s15, 1
  s_cmp_lt_u32 s15, 40313
  s_cbranch_scc1 L_mg
L_mg_ok:
  s_mov_b64 exec, -1
  v_mov_b32 v14, 0
  v_mov_b32 v116, 1
  ds_write_b32 v14, v116 offset:3856
  v_sub_f32 v112, v112, v114
  v_mul_f32 v112, s68, v112
  v_exp_f32 v112, v112
  v_rcp_f32 v115, v115
  s_nop 0
  v_mul_f32 v112, v112, v115
  v_min_u32 v113, 47, v0
  s_lshr_b32 s10, s8, 1
  s_mul_i32 s10, s10, 768
  s_and_b32 s11, s8, 1
  s_lshl_b32 s11, s11, 3
  s_add_u32 s10, s10, s11
  v_lshl_add_u32 v114, v113, 4, s10
  v_lshlrev_b32 v113, 4, v113
  v_and_b32 v115, 3, v0
  v_lshlrev_b32 v115, 4, v115
  s_mov_b32 s14, 0
L_x2_blk:
  s_lshl_b32 s10, s14, 2
  v_readlane_b32 s82, v112, s10
  s_add_u32 s10, s10, 1
  v_readlane_b32 s83, v112, s10
  s_add_u32 s10, s10, 1
  v_readlane_b32 s84, v112, s10
  s_add_u32 s10, s10, 1
  v_readlane_b32 s85, v112, s10
  s_add_u32 s10, s10, 1
  s_add_u32 s13, s14, 8
  s_mov_b32 s15, 0
L_x2w:
  ds_read_b32 v14, v115 offset:3908
  s_waitcnt lgkmcnt(0)
  v_cmp_gt_u32 vcc, s13, v14
  s_cbranch_vccz L_x2_red
  s_cmp_eq_u32 s14, 7
  s_cbranch_scc1 L_x2w_t
  s_sleep 8
  s_add_u32 s15, s15, 8
L_x2w_t:
  s_add_u32 s15, s15, 1
  s_cmp_lt_u32 s15, 1800000
  s_cbranch_scc1 L_x2w
L_x2_red:
  ds_read_b128 v[40:43], v113 offset:10240
  ds_read_b128 v[44:47], v113 offset:11008
  ds_read_b128 v[48:51], v113 offset:11776
  ds_read_b128 v[52:55], v113 offset:12544
  ds_read_b128 v[56:59], v113 offset:13312
  ds_read_b128 v[60:63], v113 offset:14080
  ds_read_b128 v[88:91], v113 offset:14848
  ds_read_b128 v[92:95], v113 offset:15616
  s_cmp_eq_u32 s69, 0
  s_waitcnt lgkmcnt(7)
  v_mul_f32 v64, s82, v40
  v_mul_f32 v65, s82, v41
  v_mul_f32 v66, s82, v42
  v_mul_f32 v67, s82, v43
  s_waitcnt lgkmcnt(6)
  v_fmac_f32 v64, s82, v44
  v_fmac_f32 v65, s82, v45
  v_fmac_f32 v66, s82, v46
  v_fmac_f32 v67, s82, v47
  s_waitcnt lgkmcnt(5)
  v_fmac_f32 v64, s83, v48
  v_fmac_f32 v65, s83, v49
  v_fmac_f32 v66, s83, v50
  v_fmac_f32 v67, s83, v51
  s_waitcnt lgkmcnt(4)
  v_fmac_f32 v64, s83, v52
  v_fmac_f32 v65, s83, v53
  v_fmac_f32 v66, s83, v54
  v_fmac_f32 v67, s83, v55
  s_waitcnt lgkmcnt(3)
  v_fmac_f32 v64, s84, v56
  v_fmac_f32 v65, s84, v57
  v_fmac_f32 v66, s84, v58
  v_fmac_f32 v67, s84, v59
  s_waitcnt lgkmcnt(2)
  v_fmac_f32 v64, s84, v60
  v_fmac_f32 v65, s84, v61
  v_fmac_f32 v66, s84, v62
  v_fmac_f32 v67, s84, v63
  s_waitcnt lgkmcnt(1)
  v_fmac_f32 v64, s85, v88
  v_fmac_f32 v65, s85, v89
  v_fmac_f32 v66, s85, v90
  v_fmac_f32 v67, s85, v91
  s_waitcnt lgkmcnt(0)
  v_fmac_f32 v64, s85, v92
  v_fmac_f32 v65, s85, v93
  v_fmac_f32 v66, s85, v94
  v_fmac_f32 v67, s85, v95
  v_cvt_pk_bf16_f32 v64, v64, v65
  v_cvt_pk_bf16_f32 v65, v66, v67
  v_min_u32 v64, -2, v64
  v_min_u32 v65, -2, v65
  s_mov_b32 exec_lo, 0xffffffff
  s_mov_b32 exec_hi, 0xffff
  s_cbranch_scc0 L_rec_far
  buffer_store_dwordx2 v[64:65], v114, s[52:55], s80 offen
  s_branch L_rec_done
L_rec_far:
  buffer_store_dwordx2 v[64:65], v114, s[52:55], s80 offen sc1
L_rec_done:
  s_mov_b64 exec, -1
  s_cmp_eq_u32 s14, 7
  s_cbranch_scc1 L_x2_end
  s_cmp_eq_u32 s14, 4
  s_cbranch_scc0 L_x2_na
  s_cmp_lt_u32 s6, 5
  s_cbranch_scc0 L_x2_na
  s_cmp_lt_u32 s8, 0
  s_cbranch_scc1 L_x2_na
  s_call_b64 s[94:95], L_stepA
L_x2_na:
  s_add_u32 s14, s14, 1
  s_add_u32 s80, s80, 12288
  v_add_u32 v113, 6144, v113
  s_branch L_x2_blk
L_x2_end:
  v_mov_b32 v13, 0
  v_mov_b32 v14, 1
  ds_write_b32 v13, v14 offset:3864
  s_cmp_lt_u32 s6, 5
  s_cbranch_scc0 L_fin
  s_cmp_lt_u32 s8, 32
  s_cbranch_scc0 L_stepB
  buffer_load_dwordx4 v[128:131], v126, s[40:43], 0 offen offset:0 nt
  buffer_load_dwordx4 v[132:135], v126, s[40:43], 0 offen offset:1280 nt
  buffer_load_dwordx4 v[136:139], v126, s[40:43], 0 offen offset:2560 nt
  buffer_load_dwordx4 v[140:143], v126, s[40:43], 0 offen offset:3840 nt
  buffer_load_dwordx4 v[144:147], v126, s[40:43], s75 offen offset:0 nt
  buffer_load_dwordx4 v[148:151], v126, s[40:43], s75 offen offset:1280 nt
  buffer_load_dwordx4 v[152:155], v126, s[40:43], s75 offen offset:2560 nt
  buffer_load_dwordx4 v[156:159], v126, s[40:43], s75 offen offset:3840 nt
  buffer_load_dwordx4 v[160:163], v126, s[40:43], s76 offen offset:0 nt
  buffer_load_dwordx4 v[164:167], v126, s[40:43], s76 offen offset:1280 nt
  buffer_load_dwordx4 v[168:171], v126, s[40:43], s76 offen offset:2560 nt
  buffer_load_dwordx4 v[172:175], v126, s[40:43], s76 offen offset:3840 nt
  s_branch L_stepB
L_x3_ctl:
  v_mov_b32 v12, 0
  s_mov_b32 s15, 0
L_x3e:
  ds_read_b32 v13, v12 offset:3908
  s_waitcnt lgkmcnt(0)
  v_cmp_gt_u32 vcc, 3, v13
  s_cbranch_vccz L_x3e_ok
  s_sleep 32
  s_add_u32 s15, s15, 1
  s_cmp_lt_u32 s15, 67669
  s_cbranch_scc1 L_x3e
L_x3e_ok:
  s_mov_b32 s15, 0
L_x3s:
  v_mov_b32 v13, 0
  buffer_load_dword v13, v13, s[56:59], 0 offen offset:0 sc1
  s_waitcnt vmcnt(0)
  v_cmp_eq_u32 vcc, 0, v13
  s_cbranch_vccz L_x3s_ok
  s_sleep 64
  s_add_u32 s15, s15, 1
  s_cmp_lt_u32 s15, 31331
  s_cbranch_scc1 L_x3s
L_x3s_ok:
  s_lshl_b32 s79, s7, 7
  s_add_u32 s79, s79, 589824
  s_xor_b32 s10, s7, 0
  s_and_b32 s10, s10, 0x87
  s_cselect_b32 s79, 4194304, s79
  v_mov_b32 v12, 0
  s_mov_b32 s15, 0
  s_mov_b64 exec, 1
  v_mov_b32 v116, 0
  v_mov_b32 v117, 0
  v_mov_b32 v118, 0
  s_mov_b32 s14, 6
L_xc:
  s_sleep 40
  ds_read_b96 v[112:114], v12 offset:3904
  s_waitcnt lgkmcnt(0)
  v_readfirstlane_b32 s11, v113
  s_add_u32 s14, s14, 1
  s_cmp_lt_u32 s14, 7
  s_cbranch_scc1 L_xc_loc
  s_cmp_ge_u32 s11, 12
  s_cbranch_scc1 L_xc_loc
  s_mov_b32 s14, 0
  buffer_load_dwordx3 v[116:118], v12, s[56:59], 0 offen offset:64 sc1
  v_mov_b32 v113, v114
  buffer_store_dwordx2 v[112:113], v12, s[52:55], s79 offen offset:4 sc1
  s_waitcnt vmcnt(1)
L_xc_loc:
  s_memrealtime s[88:89]
  s_waitcnt lgkmcnt(0)
  v_sub_u32 v13, s88, v117
  v_mul_lo_u32 v13, v13, v118
  v_ashrrev_i32 v13, 8, v13
  v_add_u32 v13, v13, v116
  ds_write_b32 v12, v13 offset:3840
  s_cmp_ge_u32 s11, 13
  s_cbranch_scc1 L_xc_done
  s_add_u32 s15, s15, 1
  s_cmp_lt_u32 s15, 54545
  s_cbranch_scc1 L_xc
L_xc_done:
  s_mov_b64 exec, -1
  s_cmp_lt_u32 s6, 5
  s_cbranch_scc0 L_fin
L_b0wait:
  v_mov_b32 v12, 0
  s_mov_b32 s15, 0
L_b0a:
  ds_read_b32 v13, v12 offset:3908
  s_waitcnt lgkmcnt(0)
  v_cmp_gt_u32 vcc, 12, v13
  s_cbranch_vccz L_b0a_ok
  s_sleep 32
  s_add_u32 s15, s15, 1
  s_cmp_lt_u32 s15, 67669
  s_cbranch_scc1 L_b0a
L_b0a_ok:
  s_mov_b32 s15, 0
L_b0b:
  ds_read_b32 v13, v12 offset:3856
  s_waitcnt lgkmcnt(0)
  v_cmp_gt_u32 vcc, 1, v13
  s_cbranch_vccz L_b0b_ok
  s_sleep 32
  s_add_u32 s15, s15, 1
  s_cmp_lt_u32 s15, 67669
  s_cbranch_scc1 L_b0b
L_b0b_ok:
  s_cmp_lt_u32 s8, 0
  s_cbranch_scc1 L_blate
  s_call_b64 s[94:95], L_stepA
L_blate:
  s_mov_b32 s15, 0
L_bend0:
  ds_read_b32 v13, v12 offset:3908
  s_waitcnt lgkmcnt(0)
  v_cmp_gt_u32 vcc, 14, v13
  s_cbranch_vccz L_bend0_ok
  s_sleep 16
  s_add_u32 s15, s15, 1
  s_cmp_lt_u32 s15, 130434
  s_cbranch_scc1 L_bend0
L_bend0_ok:
  s_cmp_lt_u32 s8, 32
  s_cbranch_scc0 L_wlb_no
  v_mov_b32 v13, 0
  s_mov_b32 s15, 0
L_wlb:
  ds_read_b32 v14, v13 offset:3860
  s_waitcnt lgkmcnt(0)
  v_cmp_gt_u32 vcc, 1, v14
  s_cbranch_vccz L_wlb_ok
  s_sleep 1
  s_add_u32 s15, s15, 1
  s_cmp_lt_u32 s15, 1000000
  s_cbranch_scc1 L_wlb
L_wlb_ok:
  buffer_load_dwordx4 v[128:131], v126, s[40:43], 0 offen offset:0 nt
  buffer_load_dwordx4 v[132:135], v126, s[40:43], 0 offen offset:1280 nt
  buffer_load_dwordx4 v[136:139], v126, s[40:43], 0 offen offset:2560 nt
  buffer_load_dwordx4 v[140:143], v126, s[40:43], 0 offen offset:3840 nt
  buffer_load_dwordx4 v[144:147], v126, s[40:43], s75 offen offset:0 nt
  buffer_load_dwordx4 v[148:151], v126, s[40:43], s75 offen offset:1280 nt
  buffer_load_dwordx4 v[152:155], v126, s[40:43], s75 offen offset:2560 nt
  buffer_load_dwordx4 v[156:159], v126, s[40:43], s75 offen offset:3840 nt
  buffer_load_dwordx4 v[160:163], v126, s[40:43], s76 offen offset:0 nt
  buffer_load_dwordx4 v[164:167], v126, s[40:43], s76 offen offset:1280 nt
  buffer_load_dwordx4 v[168:171], v126, s[40:43], s76 offen offset:2560 nt
  buffer_load_dwordx4 v[172:175], v126, s[40:43], s76 offen offset:3840 nt
L_wlb_no:
  s_mov_b32 s15, 0
L_bend:
  ds_read_b32 v13, v12 offset:3864
  s_waitcnt lgkmcnt(0)
  v_cmp_gt_u32 vcc, 1, v13
  s_cbranch_vccz L_bend_ok
  s_sleep 1
  s_add_u32 s15, s15, 1
  s_cmp_lt_u32 s15, 1000000
  s_cbranch_scc1 L_bend
L_bend_ok:
L_stepB:
  s_mov_b32 s15, 0
L_pr1:
  buffer_load_dwordx4 v[176:179], v9, s[52:55], 0 offen offset:0 sc1
  buffer_load_dwordx4 v[180:183], v9, s[52:55], 0 offen offset:3072 sc1
  buffer_load_dwordx4 v[184:187], v9, s[52:55], s78 offen offset:0 sc1
  buffer_load_dwordx4 v[188:191], v9, s[52:55], s78 offen offset:3072 sc1
  s_waitcnt vmcnt(0)
  v_max_u32 v14, v176, v177
  v_max3_u32 v14, v178, v179, v14
  v_max3_u32 v14, v180, v181, v14
  v_max3_u32 v14, v182, v183, v14
  v_max3_u32 v14, v184, v185, v14
  v_max3_u32 v14, v186, v187, v14
  v_max3_u32 v14, v188, v189, v14
  v_max3_u32 v14, v190, v191, v14
  v_cmp_eq_u32 vcc, -1, v14
  s_cbranch_vccz L_pr1_ok
  s_mov_b64 exec, vcc
  s_add_u32 s15, s15, 1
  s_cmp_lt_u32 s15, 288000
  s_cbranch_scc1 L_pr1
L_pr1_ok:
  s_mov_b64 exec, -1
  v_mfma_f32_16x16x32_bf16 v[100:103], v[176:179], v[104:107], v[100:103]
  v_mfma_f32_16x16x32_bf16 v[100:103], v[180:183], v[104:107], v[100:103]
  v_mfma_f32_16x16x32_bf16 v[100:103], v[184:187], v[104:107], v[100:103]
  v_mfma_f32_16x16x32_bf16 v[100:103], v[188:191], v[104:107], v[100:103]
  s_nop 7
  v_cvt_pk_bf16_f32 v100, v100, v100
  v_cvt_pk_bf16_f32 v101, v101, v101
  v_cvt_pk_bf16_f32 v102, v102, v102
  v_and_b32_dpp v36, v100, v2 quad_perm:[0,0,0,0] row_mask:0xf bank_mask:0xf
  v_and_b32_dpp v37, v100, v3 quad_perm:[0,0,0,0] row_mask:0xf bank_mask:0xf
  v_and_b32_dpp v38, v100, v4 quad_perm:[0,0,0,0] row_mask:0xf bank_mask:0xf
  v_and_b32_dpp v39, v100, v5 quad_perm:[0,0,0,0] row_mask:0xf bank_mask:0xf
  v_and_b32_dpp v60, v100, v2 quad_perm:[1,1,1,1] row_mask:0xf bank_mask:0xf
  v_and_b32_dpp v61, v100, v3 quad_perm:[1,1,1,1] row_mask:0xf bank_mask:0xf
  v_and_b32_dpp v62, v100, v4 quad_perm:[1,1,1,1] row_mask:0xf bank_mask:0xf
  v_and_b32_dpp v63, v100, v5 quad_perm:[1,1,1,1] row_mask:0xf bank_mask:0xf
  v_mfma_f32_16x16x32_bf16 v[68:71], v[36:39], v[128:131], 0
  v_and_b32_dpp v56, v100, v2 quad_perm:[2,2,2,2] row_mask:0xf bank_mask:0xf
  v_and_b32_dpp v57, v100, v3 quad_perm:[2,2,2,2] row_mask:0xf bank_mask:0xf
  v_and_b32_dpp v58, v100, v4 quad_perm:[2,2,2,2] row_mask:0xf bank_mask:0xf
  v_and_b32_dpp v59, v100, v5 quad_perm:[2,2,2,2] row_mask:0xf bank_mask:0xf
  v_mfma_f32_16x16x32_bf16 v[68:71], v[60:63], v[132:135], v[68:71]
  v_and_b32_dpp v36, v100, v2 quad_perm:[3,3,3,3] row_mask:0xf bank_mask:0xf
  v_and_b32_dpp v37, v100, v3 quad_perm:[3,3,3,3] row_mask:0xf bank_mask:0xf
  v_and_b32_dpp v38, v100, v4 quad_perm:[3,3,3,3] row_mask:0xf bank_mask:0xf
  v_and_b32_dpp v39, v100, v5 quad_perm:[3,3,3,3] row_mask:0xf bank_mask:0xf
  v_mfma_f32_16x16x32_bf16 v[68:71], v[56:59], v[136:139], v[68:71]
  v_and_b32_dpp v60, v101, v2 quad_perm:[0,0,0,0] row_mask:0xf bank_mask:0xf
  v_and_b32_dpp v61, v101, v3 quad_perm:[0,0,0,0] row_mask:0xf bank_mask:0xf
  v_and_b32_dpp v62, v101, v4 quad_perm:[0,0,0,0] row_mask:0xf bank_mask:0xf
  v_and_b32_dpp v63, v101, v5 quad_perm:[0,0,0,0] row_mask:0xf bank_mask:0xf
  v_mfma_f32_16x16x32_bf16 v[68:71], v[36:39], v[140:143], v[68:71]
  v_and_b32_dpp v56, v101, v2 quad_perm:[1,1,1,1] row_mask:0xf bank_mask:0xf
  v_and_b32_dpp v57, v101, v3 quad_perm:[1,1,1,1] row_mask:0xf bank_mask:0xf
  v_and_b32_dpp v58, v101, v4 quad_perm:[1,1,1,1] row_mask:0xf bank_mask:0xf
  v_and_b32_dpp v59, v101, v5 quad_perm:[1,1,1,1] row_mask:0xf bank_mask:0xf
  v_mfma_f32_16x16x32_bf16 v[68:71], v[60:63], v[144:147], v[68:71]
  v_and_b32_dpp v36, v101, v2 quad_perm:[2,2,2,2] row_mask:0xf bank_mask:0xf
  v_and_b32_dpp v37, v101, v3 quad_perm:[2,2,2,2] row_mask:0xf bank_mask:0xf
  v_and_b32_dpp v38, v101, v4 quad_perm:[2,2,2,2] row_mask:0xf bank_mask:0xf
  v_and_b32_dpp v39, v101, v5 quad_perm:[2,2,2,2] row_mask:0xf bank_mask:0xf
  v_mfma_f32_16x16x32_bf16 v[68:71], v[56:59], v[148:151], v[68:71]
  v_and_b32_dpp v60, v101, v2 quad_perm:[3,3,3,3] row_mask:0xf bank_mask:0xf
  v_and_b32_dpp v61, v101, v3 quad_perm:[3,3,3,3] row_mask:0xf bank_mask:0xf
  v_and_b32_dpp v62, v101, v4 quad_perm:[3,3,3,3] row_mask:0xf bank_mask:0xf
  v_and_b32_dpp v63, v101, v5 quad_perm:[3,3,3,3] row_mask:0xf bank_mask:0xf
  v_mfma_f32_16x16x32_bf16 v[68:71], v[36:39], v[152:155], v[68:71]
  v_and_b32_dpp v56, v102, v2 quad_perm:[0,0,0,0] row_mask:0xf bank_mask:0xf
  v_and_b32_dpp v57, v102, v3 quad_perm:[0,0,0,0] row_mask:0xf bank_mask:0xf
  v_and_b32_dpp v58, v102, v4 quad_perm:[0,0,0,0] row_mask:0xf bank_mask:0xf
  v_and_b32_dpp v59, v102, v5 quad_perm:[0,0,0,0] row_mask:0xf bank_mask:0xf
  v_mfma_f32_16x16x32_bf16 v[68:71], v[60:63], v[156:159], v[68:71]
  v_and_b32_dpp v36, v102, v2 quad_perm:[1,1,1,1] row_mask:0xf bank_mask:0xf
  v_and_b32_dpp v37, v102, v3 quad_perm:[1,1,1,1] row_mask:0xf bank_mask:0xf
  v_and_b32_dpp v38, v102, v4 quad_perm:[1,1,1,1] row_mask:0xf bank_mask:0xf
  v_and_b32_dpp v39, v102, v5 quad_perm:[1,1,1,1] row_mask:0xf bank_mask:0xf
  v_mfma_f32_16x16x32_bf16 v[68:71], v[56:59], v[160:163], v[68:71]
  v_and_b32_dpp v60, v102, v2 quad_perm:[2,2,2,2] row_mask:0xf bank_mask:0xf
  v_and_b32_dpp v61, v102, v3 quad_perm:[2,2,2,2] row_mask:0xf bank_mask:0xf
  v_and_b32_dpp v62, v102, v4 quad_perm:[2,2,2,2] row_mask:0xf bank_mask:0xf
  v_and_b32_dpp v63, v102, v5 quad_perm:[2,2,2,2] row_mask:0xf bank_mask:0xf
  v_mfma_f32_16x16x32_bf16 v[68:71], v[36:39], v[164:167], v[68:71]
  v_and_b32_dpp v56, v102, v2 quad_perm:[3,3,3,3] row_mask:0xf bank_mask:0xf
  v_and_b32_dpp v57, v102, v3 quad_perm:[3,3,3,3] row_mask:0xf bank_mask:0xf
  v_and_b32_dpp v58, v102, v4 quad_perm:[3,3,3,3] row_mask:0xf bank_mask:0xf
  v_and_b32_dpp v59, v102, v5 quad_perm:[3,3,3,3] row_mask:0xf bank_mask:0xf
  v_mfma_f32_16x16x32_bf16 v[68:71], v[60:63], v[168:171], v[68:71]
  s_nop 1
  v_mfma_f32_16x16x32_bf16 v[68:71], v[56:59], v[172:175], v[68:71]
  v_mov_b32 v13, 0
  v_mov_b32 v14, 1
  s_mov_b32 s15, 0
  s_cmp_eq_u32 s4, 4
  s_cbranch_scc1 L_ysum
  s_nop 2
  ds_write_b128 v10, v[68:71] offset:59392
  s_mov_b64 exec, 1
  ds_add_u32 v13, v14 offset:3852
  s_mov_b64 exec, -1
  s_branch L_fin
L_ysum:
  ds_read_b32 v14, v13 offset:3852
  ds_read_b128 v[44:47], v10 offset:60416
  ds_read_b128 v[48:51], v10 offset:61440
  ds_read_b128 v[52:55], v10 offset:62464
  s_waitcnt lgkmcnt(3)
  v_cmp_gt_u32 vcc, 3, v14
  s_cbranch_vccz L_ysum_ok
  s_waitcnt lgkmcnt(0)
  s_add_u32 s15, s15, 1
  s_cmp_lt_u32 s15, 1800000
  s_cbranch_scc1 L_ysum
L_ysum_ok:
  s_waitcnt lgkmcnt(2)
  v_add_f32 v68, v68, v44
  v_add_f32 v69, v69, v45
  v_add_f32 v70, v70, v46
  v_add_f32 v71, v71, v47
  s_waitcnt lgkmcnt(1)
  v_add_f32 v68, v68, v48
  v_add_f32 v69, v69, v49
  v_add_f32 v70, v70, v50
  v_add_f32 v71, v71, v51
  s_waitcnt lgkmcnt(0)
  v_add_f32 v68, v68, v52
  v_add_f32 v69, v69, v53
  v_add_f32 v70, v70, v54
  v_add_f32 v71, v71, v55
  v_min_u32 v68, -2, v68
  v_min_u32 v69, -2, v69
  v_min_u32 v70, -2, v70
  v_min_u32 v71, -2, v71
  buffer_store_dwordx4 v[68:71], v127, s[52:55], s77 offen sc1
  s_branch L_fin
L_stepA:
  s_mov_b32 s15, 0
L_pr0:
  buffer_load_dwordx4 v[176:179], v9, s[52:55], 0 offen offset:0 sc1
  buffer_load_dwordx4 v[180:183], v9, s[52:55], 0 offen offset:3072 sc1
  buffer_load_dwordx4 v[184:187], v9, s[52:55], s78 offen offset:0 sc1
  buffer_load_dwordx4 v[188:191], v9, s[52:55], s78 offen offset:3072 sc1
  s_waitcnt vmcnt(0)
  v_max_u32 v14, v176, v177
  v_max3_u32 v14, v178, v179, v14
  v_max3_u32 v14, v180, v181, v14
  v_max3_u32 v14, v182, v183, v14
  v_max3_u32 v14, v184, v185, v14
  v_max3_u32 v14, v186, v187, v14
  v_max3_u32 v14, v188, v189, v14
  v_max3_u32 v14, v190, v191, v14
  v_cmp_eq_u32 vcc, -1, v14
  s_cbranch_vccz L_pr0_ok
  s_mov_b64 exec, vcc
  s_sleep 16
  s_add_u32 s15, s15, 1
  s_cmp_lt_u32 s15, 94488
  s_cbranch_scc1 L_pr0
L_pr0_ok:
  s_mov_b64 exec, -1
  v_mfma_f32_16x16x32_bf16 v[100:103], v[176:179], v[108:111], 0
  v_mfma_f32_16x16x32_bf16 v[100:103], v[180:183], v[108:111], v[100:103]
  v_mfma_f32_16x16x32_bf16 v[100:103], v[184:187], v[108:111], v[100:103]
  v_mfma_f32_16x16x32_bf16 v[100:103], v[188:191], v[108:111], v[100:103]
  v_add_u32 v9, 49152, v9
  s_setpc_b64 s[94:95]
L_final:
L_final2:
  s_lshr_b32 s10, s8, 3
  s_mul_i32 s10, s10, 3
  s_add_u32 s10, s10, s6
  s_sub_u32 s10, s10, 5
  s_lshr_b32 s12, s10, 2
  s_lshl_b32 s12, s12, 3
  s_add_u32 s12, s12, s3
  s_lshl_b32 s12, s12, 2
  s_and_b32 s10, s10, 3
  s_add_u32 s12, s12, s10
  s_cmp_ge_u32 s12, 80
  s_cbranch_scc1 L_fin
  v_lshrrev_b32 v6, 2, v0
  v_mul_u32_u24 v6, 5120, v6
  v_and_b32 v7, 3, v0
  v_lshl_add_u32 v6, v7, 4, v6
  s_lshl_b32 s10, s12, 6
  v_add_u32 v6, s10, v6
  s_bfe_u32 s10, s12, 0x10003
  s_mul_i32 s10, s10, 640
  s_lshr_b32 s11, s12, 4
  s_lshl_b32 s11, s11, 7
  s_add_u32 s10, s10, s11
  s_and_b32 s11, s12, 7
  s_lshl_b32 s11, s11, 4
  s_add_u32 s10, s10, s11
  v_lshlrev_b32 v7, 2, v7
  v_lshrrev_b32 v10, 4, v0
  v_add3_u32 v7, v7, v10, s10
  v_lshlrev_b32 v7, 1, v7
  s_mov_b32 s64, s34
  s_mov_b32 s65, s35
  s_mov_b32 s66, 2560
  s_mov_b32 s67, 0x20000
  buffer_load_ushort v8, v7, s[60:63], 0 offen
  v_mov_b32 v12, 0
  s_mov_b32 s15, 0
L_fe:
  ds_read_b32 v13, v12 offset:3908
  s_waitcnt lgkmcnt(0)
  v_cmp_gt_u32 vcc, 8, v13
  s_cbranch_vccz L_fe_ok
  s_sleep 32
  s_add_u32 s15, s15, 1
  s_cmp_lt_u32 s15, 67669
  s_cbranch_scc1 L_fe
L_fe_ok:
  s_mov_b32 s15, 0
L_fg:
  v_mov_b32 v10, 0
  buffer_load_dword v10, v10, s[56:59], 0 offen offset:192 sc1
  s_waitcnt vmcnt(0)
  v_cmp_eq_u32 vcc, 0, v10
  s_cbranch_vccz L_fg_ok
  s_sleep 127
  s_add_u32 s15, s15, 1
  s_cmp_lt_u32 s15, 16689
  s_cbranch_scc1 L_fg
L_fg_ok:
  v_mov_b32 v128, 0
  v_mov_b32 v129, 0
  v_mov_b32 v130, 0
  v_mov_b32 v131, 0
  s_mov_b32 s10, 917504
  s_mov_b32 exec_lo, 0xffffffff
  s_mov_b32 exec_hi, 0xffff
  buffer_load_dwordx4 v[128:131], v6, s[52:55], s10 offen sc1
  s_mov_b64 exec, -1
  v_lshlrev_b32 v8, 16, v8
  s_waitcnt vmcnt(0)
  s_nop 0
  v_permlane32_swap_b32 v128, v130
  v_permlane32_swap_b32 v129, v131
  s_nop 0
  v_add_f32 v128, v128, v130
  v_add_f32 v129, v129, v131
  s_nop 1
  v_permlane16_swap_b32 v128, v129
  s_nop 1
  v_add_f32 v128, v128, v129
  s_nop 1
  v_add_f32_dpp v128, v128, v128 row_ror:4 row_mask:0xf bank_mask:0xf
  s_nop 1
  v_add_f32_dpp v128, v128, v128 row_ror:8 row_mask:0xf bank_mask:0xf
  v_cvt_pk_bf16_f32 v9, v128, v128
  v_and_b32 v9, 0xffff0000, v9
  s_mov_b32 s74, 720896
  s_mov_b32 s75, 802816
  v_mov_b32 v12, 0
  s_mov_b32 s15, 0
L_fend0:
  ds_read_b32 v13, v12 offset:3908
  s_waitcnt lgkmcnt(0)
  v_cmp_gt_u32 vcc, 14, v13
  s_cbranch_vccz L_fend0_ok
  s_sleep 32
  s_add_u32 s15, s15, 1
  s_cmp_lt_u32 s15, 67669
  s_cbranch_scc1 L_fend0
L_fend0_ok:
  s_mov_b32 s15, 0
L_fend:
  ds_read_b32 v13, v12 offset:3864
  s_waitcnt lgkmcnt(0)
  v_cmp_gt_u32 vcc, 1, v13
  s_cbranch_vccz L_fend_ok
  s_sleep 4
  s_add_u32 s15, s15, 1
  s_cmp_lt_u32 s15, 428571
  s_cbranch_scc1 L_fend
L_fend_ok:
  s_mov_b32 s15, 0
  buffer_load_dwordx4 v[176:179], v6, s[52:55], s74 offen sc1
  buffer_load_dwordx4 v[180:183], v6, s[52:55], s75 offen sc1
  s_sleep 8
  buffer_load_dwordx4 v[184:187], v6, s[52:55], s74 offen sc1
  buffer_load_dwordx4 v[188:191], v6, s[52:55], s75 offen sc1
L_y:
  s_waitcnt vmcnt(2)
  v_max_u32 v10, v176, v177
  v_max3_u32 v10, v178, v179, v10
  v_max3_u32 v10, v180, v181, v10
  v_max3_u32 v10, v182, v183, v10
  v_cmp_eq_u32 vcc, -1, v10
  s_cbranch_vccz L_y_ok0
  s_mov_b64 exec, vcc
  buffer_load_dwordx4 v[176:179], v6, s[52:55], s74 offen sc1
  buffer_load_dwordx4 v[180:183], v6, s[52:55], s75 offen sc1
  s_mov_b64 exec, -1
  s_waitcnt vmcnt(2)
  v_max_u32 v10, v184, v185
  v_max3_u32 v10, v186, v187, v10
  v_max3_u32 v10, v188, v189, v10
  v_max3_u32 v10, v190, v191, v10
  v_cmp_eq_u32 vcc, -1, v10
  s_cbranch_vccz L_y_ok1
  s_mov_b64 exec, vcc
  buffer_load_dwordx4 v[184:187], v6, s[52:55], s74 offen sc1
  buffer_load_dwordx4 v[188:191], v6, s[52:55], s75 offen sc1
  s_mov_b64 exec, -1
  s_add_u32 s15, s15, 1
  s_cmp_lt_u32 s15, 288000
  s_cbranch_scc1 L_y
  s_waitcnt vmcnt(0)
L_y_ok1:
  v_add_f32 v128, v184, v188
  v_add_f32 v129, v185, v189
  v_add_f32 v130, v186, v190
  v_add_f32 v131, v187, v191
  s_branch L_y_join
L_y_ok0:
  v_add_f32 v128, v176, v180
  v_add_f32 v129, v177, v181
  v_add_f32 v130, v178, v182
  v_add_f32 v131, v179, v183
L_y_join:
  s_nop 0
  v_permlane32_swap_b32 v128, v130
  v_permlane32_swap_b32 v129, v131
  s_nop 0
  v_add_f32 v128, v128, v130
  v_add_f32 v129, v129, v131
  s_nop 1
  v_permlane16_swap_b32 v128, v129
  s_nop 1
  v_add_f32 v128, v128, v129
  s_nop 1
  v_add_f32_dpp v128, v128, v128 row_ror:4 row_mask:0xf bank_mask:0xf
  s_nop 1
  v_add_f32_dpp v128, v128, v128 row_ror:8 row_mask:0xf bank_mask:0xf
  v_cvt_pk_bf16_f32 v128, v128, v128
  v_and_b32 v128, 0xffff0000, v128
  v_add_f32 v128, v8, v128
  v_cvt_pk_bf16_f32 v128, v128, v128
  v_and_b32 v128, 0xffff0000, v128
  v_add_f32 v128, v128, v9
  v_cvt_pk_bf16_f32 v128, v128, v128
  s_mov_b32 exec_lo, 0xf000f
  s_mov_b32 exec_hi, 0xf000f
  buffer_store_short v128, v7, s[64:67], 0 offen
  s_mov_b64 exec, -1
L_fin:
L_end:
  s_endpgm
.section .rodata,"a"
.p2align 6
.amdhsa_kernel parallel_sum__gqa_block_cached__glu_gated_glu__decode_kernel
  .amdhsa_next_free_vgpr 256
  .amdhsa_next_free_sgpr 96
  .amdhsa_accum_offset 256
  .amdhsa_group_segment_fixed_size 0
  .amdhsa_kernarg_size 96
  .amdhsa_user_sgpr_count 2
  .amdhsa_user_sgpr_kernarg_segment_ptr 1
  .amdhsa_system_sgpr_workgroup_id_x 1
  .amdhsa_float_denorm_mode_32 3
.end_amdhsa_kernel
```
